```python
import torch

def _softmax(x, axis=-1):
    return torch.softmax(x, dim=axis)
def _gelu(x):
    return torch.nn.functional.gelu(x, approximate="tanh")
def _silu(x):
    return torch.nn.functional.silu(x)
def _sigmoid(x):
    return torch.sigmoid(x)
def _layernorm(x, axis=-1, eps=1e-5):
    m = x.mean(dim=axis, keepdim=True)
    v = x.var(dim=axis, keepdim=True, unbiased=False)
    return (x - m) / torch.sqrt(v + eps)
def _scatter_add(tgt, idx, src, axis=0):
    return tgt.clone().index_add_(axis, idx, src)
def _segment_sum(src, seg, n):
    out = torch.zeros((n,) + src.shape[1:], dtype=src.dtype)
    return out.index_add_(0, seg, src)
def _pad(x, pw):
    flat = tuple(v for pair in reversed(pw) for v in pair)
    return torch.nn.functional.pad(x, flat)

kernel_name = 'concat_heads__gqa_block_cached__sliding_block_cached__decode'

def setup_inputs():

    _w = (lambda a: (lambda t: t.to(torch.bfloat16) if t.is_floating_point() else t)(torch.as_tensor(a)))
    def _A_setup():
        B, Sq, D = 4, 1, 512
        Hq, Hkv, Sk, Dh = 32, 32, 8192, 128
        assert Hq % Hkv == 0, (Hq, Hkv)
        return {
            "x": _w((lambda *s: torch.randn(*s, dtype=torch.bfloat16) * 0.8)(B, Sq, D)),
            "k_cache": _w((lambda *s: torch.randn(*s, dtype=torch.bfloat16) * 1.6)(B, Hkv, Sk, Dh)),
            "v_cache": _w((lambda *s: torch.randn(*s, dtype=torch.bfloat16) * 0.2)(B, Hkv, Sk, Dh)),
            "wq": _w((lambda *s: torch.randn(*s, dtype=torch.bfloat16) * 1.6)(D, Hq * Dh) * (D ** -0.5)),
            "wo": _w((lambda *s: torch.randn(*s, dtype=torch.bfloat16) * 0.2)(Hq * Dh, D) * ((Hq * Dh) ** -0.5)),
        }
    _A_in = _A_setup()

    def _B_setup():
        B, Sq, D = 4, 1, 512
        Hq, Hkv, Sk, Dh = 32, 32, 8192, 128
        assert Hq % Hkv == 0, (Hq, Hkv)
        return {
            "x": _w((lambda *s: torch.randn(*s, dtype=torch.bfloat16) * 0.8)(B, Sq, D)),
            "k_cache": _w((lambda *s: torch.randn(*s, dtype=torch.bfloat16) * 1.6)(B, Hkv, Sk, Dh)),
            "v_cache": _w((lambda *s: torch.randn(*s, dtype=torch.bfloat16) * 0.2)(B, Hkv, Sk, Dh)),
            "wq": _w((lambda *s: torch.randn(*s, dtype=torch.bfloat16) * 1.6)(D, Hq * Dh) * (D ** -0.5)),
            "wo": _w((lambda *s: torch.randn(*s, dtype=torch.bfloat16) * 0.2)(Hq * Dh, D) * ((Hq * Dh) ** -0.5)),
        }
    _B_in = _B_setup()

    return {
        "A_x": _A_in["x"],
        "A_k_cache": _A_in["k_cache"],
        "A_v_cache": _A_in["v_cache"],
        "A_wq": _A_in["wq"],
        "A_wo": _A_in["wo"],
        "B_x": _B_in["x"],
        "B_k_cache": _B_in["k_cache"],
        "B_v_cache": _B_in["v_cache"],
        "B_wq": _B_in["wq"],
        "B_wo": _B_in["wo"],
    }

def reference(A_x, A_k_cache, A_v_cache, A_wq, A_wo, B_x, B_k_cache, B_v_cache, B_wq, B_wo):
    def _A_ref(x, k_cache, v_cache, wq, wo):
        B, Sq, D = x.shape
        Hq, Dh = 32, 128
        Hkv = k_cache.shape[1]
        rep = Hq // Hkv
        q = (lambda x, *d: x.permute(*d))((x @ wq).reshape(B, Sq, Hq, Dh), 0, 2, 1, 3)
        k = (lambda x, n, axis: torch.repeat_interleave(x, n, dim=axis))(k_cache, rep, axis=1)
        v = (lambda x, n, axis: torch.repeat_interleave(x, n, dim=axis))(v_cache, rep, axis=1)
        scores = torch.einsum("bhqd,bhkd->bhqk", q, k) * (Dh ** -0.5)
        p = _softmax(scores, axis=-1)
        o = torch.einsum("bhqk,bhkd->bhqd", p, v)
        return (lambda x, *d: x.permute(*d))(o, 0, 2, 1, 3).reshape(B, Sq, Hq * Dh) @ wo

    def _B_ref(x, k_cache, v_cache, wq, wo):
        B, Sq, D = x.shape
        Hq, Dh = 32, 128
        Hkv, Sk = k_cache.shape[1], k_cache.shape[2]
        W = min(4096, max(256, Sk // 4))
        rep = Hq // Hkv
        q = (lambda x, *d: x.permute(*d))((x @ wq).reshape(B, Sq, Hq, Dh), 0, 2, 1, 3)
        k = (lambda x, n, axis: torch.repeat_interleave(x, n, dim=axis))(k_cache[:, :, Sk - W:, :], rep, axis=1)
        v = (lambda x, n, axis: torch.repeat_interleave(x, n, dim=axis))(v_cache[:, :, Sk - W:, :], rep, axis=1)
        scores = torch.einsum("bhqd,bhkd->bhqk", q, k) * (Dh ** -0.5)
        p = _softmax(scores, axis=-1)
        o = torch.einsum("bhqk,bhkd->bhqd", p, v)
        return (lambda x, *d: x.permute(*d))(o, 0, 2, 1, 3).reshape(B, Sq, Hq * Dh) @ wo

    a = _A_ref(A_x, A_k_cache, A_v_cache, A_wq, A_wo)
    b = _B_ref(B_x, B_k_cache, B_v_cache, B_wq, B_wo)
    return torch.concatenate([a, b], axis=-1)
```

```asm
; @launch grid=(256,1,1) block=(512,1,1) lds=49152
.amdgcn_target "amdgcn-amd-amdhsa--gfx950"
.text
.globl concat_heads__gqa_block_cached__sliding_block_cached__decode_kernel
.p2align 8
.type concat_heads__gqa_block_cached__sliding_block_cached__decode_kernel,@function
concat_heads__gqa_block_cached__sliding_block_cached__decode_kernel:
s_cmp_ge_u32 s2, 256
s_cbranch_scc1 L_end
s_load_dwordx16 s[16:31], s[0:1], 0
s_load_dwordx8 s[32:39], s[0:1], 64
s_load_dwordx2 s[40:41], s[0:1], 96
v_lshrrev_b32 v1, 6, v0
v_and_b32 v0, 63, v0
v_readfirstlane_b32 s42, v1
s_lshr_b32 s43, s2, 3
s_and_b32 s44, s2, 7
s_and_b32 s3, s2, 3
s_mov_b32 s45, s3
s_lshr_b32 s46, s44, 2
s_mul_i32 s47, s3, 2
s_add_u32 s47, s47, s43
s_and_b32 s47, s47, 7
s_cmp_lt_u32 s47, 1
s_cselect_b32 s51, 1, 0
s_mov_b32 s7, 0x20000
s_mov_b32 s11, 0x20000
s_mov_b32 s10, 6291456
s_mov_b32 s76, 0xffffff00
s_cmp_ge_u32 s42, 4
s_cbranch_scc0 L_stream
s_sub_u32 s42, s42, 4
v_lshrrev_b32 v2, 4, v0
v_and_b32 v3, 15, v0
v_lshlrev_b32 v4, 16, v2
v_lshl_add_u32 v4, v3, 4, v4
v_lshrrev_b32 v5, 3, v3
v_lshlrev_b32 v5, 10, v5
v_lshl_add_u32 v5, v2, 4, v5
s_lshl_b32 s47, s3, 7
s_lshl_b32 s48, s42, 5
s_add_u32 s47, s47, s48
s_lshl_b32 s48, s47, 1
s_lshl_b32 s47, s47, 13
s_lshl_b32 s49, s43, 8
s_add_u32 s47, s47, s49
s_mov_b32 s6, 0x400000
s_mov_b32 s14, 4096
s_mov_b32 s15, 0x20000
s_cmp_eq_u32 s46, 0
s_waitcnt lgkmcnt(0)
s_cselect_b64 s[4:5], s[22:23], s[32:33]
s_cselect_b64 s[12:13], s[16:17], s[26:27]
buffer_load_dwordx4 v[16:19], v4, s[4:7], s47 offen nt
s_add_u32 s47, s47, 8192
buffer_load_dwordx4 v[20:23], v4, s[4:7], s47 offen nt
s_add_u32 s47, s47, 8192
buffer_load_dwordx4 v[24:27], v4, s[4:7], s47 offen nt
s_add_u32 s47, s47, 8192
buffer_load_dwordx4 v[28:31], v4, s[4:7], s47 offen nt
s_add_u32 s47, s47, 8192
buffer_load_dwordx4 v[32:35], v4, s[4:7], s47 offen nt
s_add_u32 s47, s47, 8192
buffer_load_dwordx4 v[36:39], v4, s[4:7], s47 offen nt
s_add_u32 s47, s47, 8192
buffer_load_dwordx4 v[40:43], v4, s[4:7], s47 offen nt
s_add_u32 s47, s47, 8192
buffer_load_dwordx4 v[44:47], v4, s[4:7], s47 offen nt
buffer_load_dwordx4 v[8:11], v5, s[12:15], s48 offen offset:0
buffer_load_dwordx4 v[12:15], v5, s[12:15], s48 offen offset:2048
s_branch L_service2
L_stream:
v_lshlrev_b32 v6, 4, v0
v_bfe_u32 v3, v0, 4, 1
v_lshl_add_u32 v2, v3, 15, v6
v_lshrrev_b32 v3, 5, v0
v_lshl_add_u32 v2, v3, 13, v2
s_lshl_b32 s47, s42, 8
s_lshl_b32 s48, s46, 13
s_or_b32 s47, s47, s48
v_xor_b32 v2, s47, v2
v_xor_b32 v3, 256, v2
v_xor_b32 v4, 66048, v2
v_xor_b32 v5, 66304, v2
s_lshl_b32 s47, s45, 5
s_add_u32 s47, s47, s43
s_lshl_b32 s72, s47, 21
s_and_b32 s47, s42, 1
s_lshl_b32 s47, s47, 12
s_add_u32 s72, s72, s47
s_lshr_b32 s47, s42, 1
s_lshl_b32 s47, s47, 14
s_add_u32 s72, s72, s47
s_add_u32 s53, s72, 0x180000
s_mov_b32 s6, 0x10000000
s_mov_b32 s55, 0
s_cmp_eq_u32 s51, 1
s_waitcnt lgkmcnt(0)
s_mov_b32 s4, s28
s_mov_b32 s5, s29
s_cbranch_scc1 L_late0
buffer_load_dwordx4 v[124:127], v2, s[4:7], s53 offen offset:0 nt
buffer_load_dwordx4 v[128:131], v2, s[4:7], s53 offen offset:1024 nt
buffer_load_dwordx4 v[132:135], v2, s[4:7], s53 offen offset:2048 nt
buffer_load_dwordx4 v[136:139], v2, s[4:7], s53 offen offset:3072 nt
buffer_load_dwordx4 v[140:143], v3, s[4:7], s53 offen offset:0 nt
buffer_load_dwordx4 v[144:147], v3, s[4:7], s53 offen offset:1024 nt
s_branch L_late0b
L_late0:
s_buffer_load_dword s101, s[4:7], s53
L_late0b:
s_mov_b32 s74, 1376256
s_load_dword s74, s[40:41], s74
s_mov_b32 s8, s40
s_mov_b32 s9, s41
s_mov_b32 s60, 0xcccccccc
s_mov_b32 s61, 0xcccccccc
s_mov_b32 s62, 0xaaaaaaaa
s_mov_b32 s63, 0xaaaaaaaa
s_mov_b32 s64, 0x3e0293ee
v_and_b32 v20, 15, v0
v_lshlrev_b32 v1, 4, v20
v_and_b32 v21, 1, v0
v_lshlrev_b32 v21, 4, v21
v_mov_b32 v22, 0xffff
v_lshlrev_b32 v22, v21, v22
v_lshrrev_b32 v20, 1, v20
v_cmp_eq_u32 vcc, 4, v20
v_mov_b32 v48, 0
v_mov_b32 v12, 0xff800000
v_cndmask_b32 v44, 0, v22, vcc
v_cmp_eq_u32 vcc, 5, v20
v_mov_b32 v49, 0
v_mov_b32 v13, 0xff800000
v_cndmask_b32 v45, 0, v22, vcc
v_cmp_eq_u32 vcc, 6, v20
v_mov_b32 v50, 0
v_mov_b32 v14, 0xff800000
v_cndmask_b32 v46, 0, v22, vcc
v_cmp_eq_u32 vcc, 7, v20
v_mov_b32 v51, 0
v_mov_b32 v15, 0xff800000
v_cndmask_b32 v47, 0, v22, vcc
v_mov_b32 v16, 0xff800000
s_mov_b32 s70, 0x01810190
s_mov_b32 s71, 0x00000191
s_mov_b32 s78, 0xfe0001e0
s_mov_b32 s79, 0x000001ff
s_mov_b32 s86, 0x01010010
s_mov_b32 s87, 0x00000000
s_cmp_eq_u32 s42, 0
s_cselect_b32 s56, 0x24444440, 0
s_cselect_b32 s57, 0x00000015, 0
s_lshl_b32 s58, s43, 8
s_add_u32 s58, s58, 1441792
s_mov_b32 s68, 0x210
s_mov_b32 s50, 0
s_mov_b32 s66, 0
s_mov_b32 s77, 0
s_mov_b32 s67, 0
s_mov_b32 s54, 4
s_mov_b32 s73, 2
s_cmp_eq_u32 s46, 0
s_cselect_b64 s[12:13], s[24:25], s[34:35]
s_mov_b32 s14, 0x400000
s_mov_b32 s15, 0x20000
s_cmp_eq_u32 s51, 0
s_cbranch_scc0 L_late2o
L_late2:
s_barrier
s_cmp_eq_u32 s51, 0
s_cbranch_scc0 L_late1o
L_late1:
s_cmp_eq_u32 s51, 1
s_waitcnt vmcnt(7)
s_cbranch_scc1 L_pf6
s_waitcnt vmcnt(5)
L_pf6:
buffer_load_dwordx4 v[148:151], v3, s[4:7], s53 offen offset:2048 nt
s_waitcnt vmcnt(7)
s_cbranch_scc1 L_pf7
s_waitcnt vmcnt(5)
L_pf7:
buffer_load_dwordx4 v[152:155], v3, s[4:7], s53 offen offset:3072 nt
s_waitcnt vmcnt(7)
s_cbranch_scc1 L_pf8
s_waitcnt vmcnt(5)
L_pf8:
buffer_load_dwordx4 v[156:159], v4, s[4:7], s53 offen offset:0 nt
s_waitcnt vmcnt(7)
s_cbranch_scc1 L_pf9
s_waitcnt vmcnt(5)
L_pf9:
buffer_load_dwordx4 v[160:163], v4, s[4:7], s53 offen offset:1024 nt
s_waitcnt vmcnt(7)
s_cbranch_scc1 L_pf10
s_waitcnt vmcnt(5)
L_pf10:
buffer_load_dwordx4 v[164:167], v4, s[4:7], s53 offen offset:2048 nt
s_waitcnt vmcnt(7)
s_cbranch_scc1 L_pf11
s_waitcnt vmcnt(5)
L_pf11:
buffer_load_dwordx4 v[168:171], v4, s[4:7], s53 offen offset:3072 nt
s_waitcnt vmcnt(7)
s_cbranch_scc1 L_pf12
s_waitcnt vmcnt(5)
L_pf12:
buffer_load_dwordx4 v[172:175], v5, s[4:7], s53 offen offset:0 nt
s_waitcnt vmcnt(7)
s_cbranch_scc1 L_pf13
s_waitcnt vmcnt(5)
L_pf13:
buffer_load_dwordx4 v[176:179], v5, s[4:7], s53 offen offset:1024 nt
s_waitcnt vmcnt(7)
s_cbranch_scc1 L_pf14
s_waitcnt vmcnt(5)
L_pf14:
buffer_load_dwordx4 v[180:183], v5, s[4:7], s53 offen offset:2048 nt
s_waitcnt vmcnt(7)
s_cbranch_scc1 L_pf15
s_waitcnt vmcnt(5)
L_pf15:
buffer_load_dwordx4 v[184:187], v5, s[4:7], s53 offen offset:3072 nt
s_add_u32 s53, s53, 0x20000
s_cmp_eq_u32 s51, 1
s_waitcnt vmcnt(7)
s_cbranch_scc1 L_pf16
s_waitcnt vmcnt(5)
L_pf16:
buffer_load_dwordx4 v[188:191], v2, s[4:7], s53 offen offset:0 nt
s_waitcnt vmcnt(7)
s_cbranch_scc1 L_pf17
s_waitcnt vmcnt(5)
L_pf17:
buffer_load_dwordx4 v[192:195], v2, s[4:7], s53 offen offset:1024 nt
s_waitcnt vmcnt(7)
s_cbranch_scc1 L_pf18
s_waitcnt vmcnt(5)
L_pf18:
buffer_load_dwordx4 v[196:199], v2, s[4:7], s53 offen offset:2048 nt
s_waitcnt vmcnt(7)
s_cbranch_scc1 L_pf19
s_waitcnt vmcnt(5)
L_pf19:
buffer_load_dwordx4 v[200:203], v2, s[4:7], s53 offen offset:3072 nt
s_waitcnt vmcnt(7)
s_cbranch_scc1 L_pf20
s_waitcnt vmcnt(5)
L_pf20:
buffer_load_dwordx4 v[204:207], v3, s[4:7], s53 offen offset:0 nt
s_waitcnt vmcnt(7)
s_cbranch_scc1 L_pf21
s_waitcnt vmcnt(5)
L_pf21:
buffer_load_dwordx4 v[208:211], v3, s[4:7], s53 offen offset:1024 nt
s_waitcnt vmcnt(7)
s_cbranch_scc1 L_pf22
s_waitcnt vmcnt(5)
L_pf22:
buffer_load_dwordx4 v[212:215], v3, s[4:7], s53 offen offset:2048 nt
s_waitcnt vmcnt(7)
s_cbranch_scc1 L_pf23
s_waitcnt vmcnt(5)
L_pf23:
buffer_load_dwordx4 v[216:219], v3, s[4:7], s53 offen offset:3072 nt
s_waitcnt vmcnt(7)
s_cbranch_scc1 L_pf24
s_waitcnt vmcnt(5)
L_pf24:
buffer_load_dwordx4 v[220:223], v4, s[4:7], s53 offen offset:0 nt
s_waitcnt vmcnt(7)
s_cbranch_scc1 L_pf25
s_waitcnt vmcnt(5)
L_pf25:
buffer_load_dwordx4 v[224:227], v4, s[4:7], s53 offen offset:1024 nt
s_waitcnt vmcnt(7)
s_cbranch_scc1 L_pf26
s_waitcnt vmcnt(5)
L_pf26:
buffer_load_dwordx4 v[228:231], v4, s[4:7], s53 offen offset:2048 nt
s_waitcnt vmcnt(7)
s_cbranch_scc1 L_pf27
s_waitcnt vmcnt(5)
L_pf27:
buffer_load_dwordx4 v[232:235], v4, s[4:7], s53 offen offset:3072 nt
s_waitcnt vmcnt(7)
s_cbranch_scc1 L_pf28
s_waitcnt vmcnt(5)
L_pf28:
buffer_load_dwordx4 v[236:239], v5, s[4:7], s53 offen offset:0 nt
s_waitcnt vmcnt(7)
s_cbranch_scc1 L_pf29
s_waitcnt vmcnt(5)
L_pf29:
buffer_load_dwordx4 v[240:243], v5, s[4:7], s53 offen offset:1024 nt
s_waitcnt vmcnt(7)
s_cbranch_scc1 L_pf30
s_waitcnt vmcnt(5)
L_pf30:
buffer_load_dwordx4 v[244:247], v5, s[4:7], s53 offen offset:2048 nt
s_waitcnt vmcnt(7)
s_cbranch_scc1 L_pf31
s_waitcnt vmcnt(5)
L_pf31:
buffer_load_dwordx4 v[248:251], v5, s[4:7], s53 offen offset:3072 nt
s_add_u32 s53, s53, 0x20000
s_cmp_eq_u32 s51, 1
s_waitcnt vmcnt(7)
s_cbranch_scc1 L_pf32
s_waitcnt vmcnt(5)
L_pf32:
buffer_load_dwordx4 v[60:63], v2, s[4:7], s53 offen offset:0 nt
s_waitcnt vmcnt(7)
s_cbranch_scc1 L_pf33
s_waitcnt vmcnt(5)
L_pf33:
buffer_load_dwordx4 v[64:67], v2, s[4:7], s53 offen offset:1024 nt
s_waitcnt vmcnt(7)
s_cbranch_scc1 L_pf34
s_waitcnt vmcnt(5)
L_pf34:
buffer_load_dwordx4 v[68:71], v2, s[4:7], s53 offen offset:2048 nt
s_waitcnt vmcnt(7)
s_cbranch_scc1 L_pf35
s_waitcnt vmcnt(5)
L_pf35:
buffer_load_dwordx4 v[72:75], v2, s[4:7], s53 offen offset:3072 nt
s_waitcnt vmcnt(7)
s_cbranch_scc1 L_pf36
s_waitcnt vmcnt(5)
L_pf36:
buffer_load_dwordx4 v[76:79], v3, s[4:7], s53 offen offset:0 nt
s_waitcnt vmcnt(7)
s_cbranch_scc1 L_pf37
s_waitcnt vmcnt(5)
L_pf37:
buffer_load_dwordx4 v[80:83], v3, s[4:7], s53 offen offset:1024 nt
s_waitcnt vmcnt(7)
s_cbranch_scc1 L_pf38
s_waitcnt vmcnt(5)
L_pf38:
buffer_load_dwordx4 v[84:87], v3, s[4:7], s53 offen offset:2048 nt
s_waitcnt vmcnt(7)
s_cbranch_scc1 L_pf39
s_waitcnt vmcnt(5)
L_pf39:
buffer_load_dwordx4 v[88:91], v3, s[4:7], s53 offen offset:3072 nt
s_waitcnt vmcnt(7)
s_cbranch_scc1 L_pf40
s_waitcnt vmcnt(5)
L_pf40:
buffer_load_dwordx4 v[92:95], v4, s[4:7], s53 offen offset:0 nt
s_waitcnt vmcnt(7)
s_cbranch_scc1 L_pf41
s_waitcnt vmcnt(5)
L_pf41:
buffer_load_dwordx4 v[96:99], v4, s[4:7], s53 offen offset:1024 nt
s_waitcnt vmcnt(7)
s_cbranch_scc1 L_pf42
s_waitcnt vmcnt(5)
L_pf42:
buffer_load_dwordx4 v[100:103], v4, s[4:7], s53 offen offset:2048 nt
s_waitcnt vmcnt(7)
s_cbranch_scc1 L_pf43
s_waitcnt vmcnt(5)
L_pf43:
buffer_load_dwordx4 v[104:107], v4, s[4:7], s53 offen offset:3072 nt
s_waitcnt vmcnt(7)
s_cbranch_scc1 L_pf44
s_waitcnt vmcnt(5)
L_pf44:
buffer_load_dwordx4 v[108:111], v5, s[4:7], s53 offen offset:0 nt
s_waitcnt vmcnt(7)
s_cbranch_scc1 L_pf45
s_waitcnt vmcnt(5)
L_pf45:
buffer_load_dwordx4 v[112:115], v5, s[4:7], s53 offen offset:1024 nt
v_mov_b32 v7, 0
ds_read_b32 v56, v7 offset:592
ds_read_b128 v[8:11], v1 offset:256
s_waitcnt vmcnt(7)
s_cbranch_scc1 L_pf46
s_waitcnt vmcnt(5)
L_pf46:
buffer_load_dwordx4 v[116:119], v5, s[4:7], s53 offen offset:2048 nt
s_waitcnt vmcnt(7)
s_cbranch_scc1 L_pf47
s_waitcnt vmcnt(5)
L_pf47:
buffer_load_dwordx4 v[120:123], v5, s[4:7], s53 offen offset:3072 nt
s_add_u32 s53, s53, 0x20000
s_waitcnt lgkmcnt(0)
v_cmp_ne_u32 vcc, 0, v56
s_cbranch_vccz L_qok
s_mov_b32 s52, 1048576
L_sp5:
ds_read_b32 v56, v7 offset:592
ds_read_b128 v[8:11], v1 offset:256
s_sub_u32 s52, s52, 1
s_cbranch_scc1 L_sp5x
s_waitcnt lgkmcnt(0)
v_cmp_ne_u32 vcc, 0, v56
s_cbranch_vccnz L_sp5
L_sp5x:
s_waitcnt lgkmcnt(0)
L_qok:
v_dot2_f32_bf16 v20, v60, v8, 0
v_dot2_f32_bf16 v20, v61, v9, v20
v_dot2_f32_bf16 v20, v62, v10, v20
v_dot2_f32_bf16 v20, v63, v11, v20
s_cmp_eq_u32 s51, 1
s_waitcnt vmcnt(7)
s_cbranch_scc1 L_cf0
s_waitcnt vmcnt(6)
L_cf0:
buffer_load_dwordx4 v[60:63], v2, s[4:7], s53 offen offset:0 nt
v_dot2_f32_bf16 v28, v124, v8, 0
v_dot2_f32_bf16 v28, v125, v9, v28
v_dot2_f32_bf16 v28, v126, v10, v28
v_dot2_f32_bf16 v28, v127, v11, v28
v_dot2_f32_bf16 v36, v188, v8, 0
v_dot2_f32_bf16 v36, v189, v9, v36
v_dot2_f32_bf16 v36, v190, v10, v36
v_dot2_f32_bf16 v36, v191, v11, v36
v_dot2_f32_bf16 v21, v64, v8, 0
v_dot2_f32_bf16 v21, v65, v9, v21
v_dot2_f32_bf16 v21, v66, v10, v21
v_dot2_f32_bf16 v21, v67, v11, v21
v_add_f32_dpp v23, v20, v20 row_ror:8 row_mask:0xf bank_mask:0x3
s_waitcnt vmcnt(7)
s_cbranch_scc1 L_cf1
s_waitcnt vmcnt(6)
L_cf1:
buffer_load_dwordx4 v[64:67], v2, s[4:7], s53 offen offset:1024 nt
v_dot2_f32_bf16 v29, v128, v8, 0
v_dot2_f32_bf16 v29, v129, v9, v29
v_dot2_f32_bf16 v29, v130, v10, v29
v_dot2_f32_bf16 v29, v131, v11, v29
v_add_f32_dpp v31, v28, v28 row_ror:8 row_mask:0xf bank_mask:0x3
v_dot2_f32_bf16 v37, v192, v8, 0
v_dot2_f32_bf16 v37, v193, v9, v37
v_dot2_f32_bf16 v37, v194, v10, v37
v_dot2_f32_bf16 v37, v195, v11, v37
v_add_f32_dpp v39, v36, v36 row_ror:8 row_mask:0xf bank_mask:0x3
v_dot2_f32_bf16 v22, v68, v8, 0
v_dot2_f32_bf16 v22, v69, v9, v22
v_dot2_f32_bf16 v22, v70, v10, v22
v_dot2_f32_bf16 v22, v71, v11, v22
v_add_f32_dpp v23, v21, v21 row_ror:8 row_mask:0xf bank_mask:0xc
s_waitcnt vmcnt(7)
s_cbranch_scc1 L_cf2
s_waitcnt vmcnt(6)
L_cf2:
buffer_load_dwordx4 v[68:71], v2, s[4:7], s53 offen offset:2048 nt
v_dot2_f32_bf16 v30, v132, v8, 0
v_dot2_f32_bf16 v30, v133, v9, v30
v_dot2_f32_bf16 v30, v134, v10, v30
v_dot2_f32_bf16 v30, v135, v11, v30
v_add_f32_dpp v31, v29, v29 row_ror:8 row_mask:0xf bank_mask:0xc
v_dot2_f32_bf16 v38, v196, v8, 0
v_dot2_f32_bf16 v38, v197, v9, v38
v_dot2_f32_bf16 v38, v198, v10, v38
v_dot2_f32_bf16 v38, v199, v11, v38
v_add_f32_dpp v39, v37, v37 row_ror:8 row_mask:0xf bank_mask:0xc
v_dot2_f32_bf16 v20, v72, v8, 0
v_dot2_f32_bf16 v20, v73, v9, v20
v_dot2_f32_bf16 v20, v74, v10, v20
v_dot2_f32_bf16 v20, v75, v11, v20
v_add_f32_dpp v25, v23, v23 row_half_mirror row_mask:0xf bank_mask:0x5
v_add_f32_dpp v24, v22, v22 row_ror:8 row_mask:0xf bank_mask:0x3
s_waitcnt vmcnt(7)
s_cbranch_scc1 L_cf3
s_waitcnt vmcnt(6)
L_cf3:
buffer_load_dwordx4 v[72:75], v2, s[4:7], s53 offen offset:3072 nt
v_dot2_f32_bf16 v28, v136, v8, 0
v_dot2_f32_bf16 v28, v137, v9, v28
v_dot2_f32_bf16 v28, v138, v10, v28
v_dot2_f32_bf16 v28, v139, v11, v28
v_add_f32_dpp v33, v31, v31 row_half_mirror row_mask:0xf bank_mask:0x5
v_add_f32_dpp v32, v30, v30 row_ror:8 row_mask:0xf bank_mask:0x3
v_dot2_f32_bf16 v36, v200, v8, 0
v_dot2_f32_bf16 v36, v201, v9, v36
v_dot2_f32_bf16 v36, v202, v10, v36
v_dot2_f32_bf16 v36, v203, v11, v36
v_add_f32_dpp v41, v39, v39 row_half_mirror row_mask:0xf bank_mask:0x5
v_add_f32_dpp v40, v38, v38 row_ror:8 row_mask:0xf bank_mask:0x3
v_dot2_f32_bf16 v21, v76, v8, 0
v_dot2_f32_bf16 v21, v77, v9, v21
v_dot2_f32_bf16 v21, v78, v10, v21
v_dot2_f32_bf16 v21, v79, v11, v21
v_add_f32_dpp v24, v20, v20 row_ror:8 row_mask:0xf bank_mask:0xc
s_waitcnt vmcnt(7)
s_cbranch_scc1 L_cf4
s_waitcnt vmcnt(6)
L_cf4:
buffer_load_dwordx4 v[76:79], v3, s[4:7], s53 offen offset:0 nt
v_dot2_f32_bf16 v29, v140, v8, 0
v_dot2_f32_bf16 v29, v141, v9, v29
v_dot2_f32_bf16 v29, v142, v10, v29
v_dot2_f32_bf16 v29, v143, v11, v29
v_add_f32_dpp v32, v28, v28 row_ror:8 row_mask:0xf bank_mask:0xc
v_dot2_f32_bf16 v37, v204, v8, 0
v_dot2_f32_bf16 v37, v205, v9, v37
v_dot2_f32_bf16 v37, v206, v10, v37
v_dot2_f32_bf16 v37, v207, v11, v37
v_add_f32_dpp v40, v36, v36 row_ror:8 row_mask:0xf bank_mask:0xc
v_dot2_f32_bf16 v22, v80, v8, 0
v_dot2_f32_bf16 v22, v81, v9, v22
v_dot2_f32_bf16 v22, v82, v10, v22
v_dot2_f32_bf16 v22, v83, v11, v22
v_add_f32_dpp v25, v24, v24 row_half_mirror row_mask:0xf bank_mask:0xa
v_add_f32_dpp v23, v21, v21 row_ror:8 row_mask:0xf bank_mask:0x3
s_waitcnt vmcnt(7)
s_cbranch_scc1 L_cf5
s_waitcnt vmcnt(6)
L_cf5:
buffer_load_dwordx4 v[80:83], v3, s[4:7], s53 offen offset:1024 nt
v_dot2_f32_bf16 v30, v144, v8, 0
v_dot2_f32_bf16 v30, v145, v9, v30
v_dot2_f32_bf16 v30, v146, v10, v30
v_dot2_f32_bf16 v30, v147, v11, v30
v_add_f32_dpp v33, v32, v32 row_half_mirror row_mask:0xf bank_mask:0xa
v_add_f32_dpp v31, v29, v29 row_ror:8 row_mask:0xf bank_mask:0x3
v_dot2_f32_bf16 v38, v208, v8, 0
v_dot2_f32_bf16 v38, v209, v9, v38
v_dot2_f32_bf16 v38, v210, v10, v38
v_dot2_f32_bf16 v38, v211, v11, v38
v_add_f32_dpp v41, v40, v40 row_half_mirror row_mask:0xf bank_mask:0xa
v_add_f32_dpp v39, v37, v37 row_ror:8 row_mask:0xf bank_mask:0x3
v_dot2_f32_bf16 v20, v84, v8, 0
v_dot2_f32_bf16 v20, v85, v9, v20
v_dot2_f32_bf16 v20, v86, v10, v20
v_dot2_f32_bf16 v20, v87, v11, v20
v_add_f32_dpp v25, v25, v25 quad_perm:[2,3,0,1] row_mask:0xf bank_mask:0xf
v_add_f32_dpp v23, v22, v22 row_ror:8 row_mask:0xf bank_mask:0xc
s_waitcnt vmcnt(7)
s_cbranch_scc1 L_cf6
s_waitcnt vmcnt(6)
L_cf6:
buffer_load_dwordx4 v[84:87], v3, s[4:7], s53 offen offset:2048 nt
v_dot2_f32_bf16 v28, v148, v8, 0
v_dot2_f32_bf16 v28, v149, v9, v28
v_dot2_f32_bf16 v28, v150, v10, v28
v_dot2_f32_bf16 v28, v151, v11, v28
v_add_f32_dpp v33, v33, v33 quad_perm:[2,3,0,1] row_mask:0xf bank_mask:0xf
v_add_f32_dpp v31, v30, v30 row_ror:8 row_mask:0xf bank_mask:0xc
v_dot2_f32_bf16 v36, v212, v8, 0
v_dot2_f32_bf16 v36, v213, v9, v36
v_dot2_f32_bf16 v36, v214, v10, v36
v_dot2_f32_bf16 v36, v215, v11, v36
v_add_f32_dpp v41, v41, v41 quad_perm:[2,3,0,1] row_mask:0xf bank_mask:0xf
v_add_f32_dpp v39, v38, v38 row_ror:8 row_mask:0xf bank_mask:0xc
v_dot2_f32_bf16 v21, v88, v8, 0
v_dot2_f32_bf16 v21, v89, v9, v21
v_dot2_f32_bf16 v21, v90, v10, v21
v_dot2_f32_bf16 v21, v91, v11, v21
v_add_f32_dpp v26, v23, v23 row_half_mirror row_mask:0xf bank_mask:0x5
v_add_f32_dpp v24, v20, v20 row_ror:8 row_mask:0xf bank_mask:0x3
s_waitcnt vmcnt(7)
s_cbranch_scc1 L_cf7
s_waitcnt vmcnt(6)
L_cf7:
buffer_load_dwordx4 v[88:91], v3, s[4:7], s53 offen offset:3072 nt
v_dot2_f32_bf16 v29, v152, v8, 0
v_dot2_f32_bf16 v29, v153, v9, v29
v_dot2_f32_bf16 v29, v154, v10, v29
v_dot2_f32_bf16 v29, v155, v11, v29
v_add_f32_dpp v34, v31, v31 row_half_mirror row_mask:0xf bank_mask:0x5
v_add_f32_dpp v32, v28, v28 row_ror:8 row_mask:0xf bank_mask:0x3
v_dot2_f32_bf16 v37, v216, v8, 0
v_dot2_f32_bf16 v37, v217, v9, v37
v_dot2_f32_bf16 v37, v218, v10, v37
v_dot2_f32_bf16 v37, v219, v11, v37
v_add_f32_dpp v42, v39, v39 row_half_mirror row_mask:0xf bank_mask:0x5
v_add_f32_dpp v40, v36, v36 row_ror:8 row_mask:0xf bank_mask:0x3
v_dot2_f32_bf16 v22, v92, v8, 0
v_dot2_f32_bf16 v22, v93, v9, v22
v_dot2_f32_bf16 v22, v94, v10, v22
v_dot2_f32_bf16 v22, v95, v11, v22
v_add_f32_dpp v24, v21, v21 row_ror:8 row_mask:0xf bank_mask:0xc
s_waitcnt vmcnt(7)
s_cbranch_scc1 L_cf8
s_waitcnt vmcnt(6)
L_cf8:
buffer_load_dwordx4 v[92:95], v4, s[4:7], s53 offen offset:0 nt
v_dot2_f32_bf16 v30, v156, v8, 0
v_dot2_f32_bf16 v30, v157, v9, v30
v_dot2_f32_bf16 v30, v158, v10, v30
v_dot2_f32_bf16 v30, v159, v11, v30
v_add_f32_dpp v32, v29, v29 row_ror:8 row_mask:0xf bank_mask:0xc
v_dot2_f32_bf16 v38, v220, v8, 0
v_dot2_f32_bf16 v38, v221, v9, v38
v_dot2_f32_bf16 v38, v222, v10, v38
v_dot2_f32_bf16 v38, v223, v11, v38
v_add_f32_dpp v40, v37, v37 row_ror:8 row_mask:0xf bank_mask:0xc
v_dot2_f32_bf16 v20, v96, v8, 0
v_dot2_f32_bf16 v20, v97, v9, v20
v_dot2_f32_bf16 v20, v98, v10, v20
v_dot2_f32_bf16 v20, v99, v11, v20
v_add_f32_dpp v26, v24, v24 row_half_mirror row_mask:0xf bank_mask:0xa
v_add_f32_dpp v23, v22, v22 row_ror:8 row_mask:0xf bank_mask:0x3
s_waitcnt vmcnt(7)
s_cbranch_scc1 L_cf9
s_waitcnt vmcnt(6)
L_cf9:
buffer_load_dwordx4 v[96:99], v4, s[4:7], s53 offen offset:1024 nt
v_dot2_f32_bf16 v28, v160, v8, 0
v_dot2_f32_bf16 v28, v161, v9, v28
v_dot2_f32_bf16 v28, v162, v10, v28
v_dot2_f32_bf16 v28, v163, v11, v28
v_add_f32_dpp v34, v32, v32 row_half_mirror row_mask:0xf bank_mask:0xa
v_add_f32_dpp v31, v30, v30 row_ror:8 row_mask:0xf bank_mask:0x3
v_dot2_f32_bf16 v36, v224, v8, 0
v_dot2_f32_bf16 v36, v225, v9, v36
v_dot2_f32_bf16 v36, v226, v10, v36
v_dot2_f32_bf16 v36, v227, v11, v36
v_add_f32_dpp v42, v40, v40 row_half_mirror row_mask:0xf bank_mask:0xa
v_add_f32_dpp v39, v38, v38 row_ror:8 row_mask:0xf bank_mask:0x3
v_dot2_f32_bf16 v21, v100, v8, 0
v_dot2_f32_bf16 v21, v101, v9, v21
v_dot2_f32_bf16 v21, v102, v10, v21
v_dot2_f32_bf16 v21, v103, v11, v21
v_add_f32_dpp v26, v26, v26 quad_perm:[2,3,0,1] row_mask:0xf bank_mask:0xf
v_cndmask_b32 v27, v25, v26, s[60:61]
v_add_f32_dpp v23, v20, v20 row_ror:8 row_mask:0xf bank_mask:0xc
s_waitcnt vmcnt(7)
s_cbranch_scc1 L_cf10
s_waitcnt vmcnt(6)
L_cf10:
buffer_load_dwordx4 v[100:103], v4, s[4:7], s53 offen offset:2048 nt
v_dot2_f32_bf16 v29, v164, v8, 0
v_dot2_f32_bf16 v29, v165, v9, v29
v_dot2_f32_bf16 v29, v166, v10, v29
v_dot2_f32_bf16 v29, v167, v11, v29
v_add_f32_dpp v34, v34, v34 quad_perm:[2,3,0,1] row_mask:0xf bank_mask:0xf
v_cndmask_b32 v35, v33, v34, s[60:61]
v_add_f32_dpp v31, v28, v28 row_ror:8 row_mask:0xf bank_mask:0xc
v_dot2_f32_bf16 v37, v228, v8, 0
v_dot2_f32_bf16 v37, v229, v9, v37
v_dot2_f32_bf16 v37, v230, v10, v37
v_dot2_f32_bf16 v37, v231, v11, v37
v_add_f32_dpp v42, v42, v42 quad_perm:[2,3,0,1] row_mask:0xf bank_mask:0xf
v_cndmask_b32 v43, v41, v42, s[60:61]
v_add_f32_dpp v39, v36, v36 row_ror:8 row_mask:0xf bank_mask:0xc
v_dot2_f32_bf16 v22, v104, v8, 0
v_dot2_f32_bf16 v22, v105, v9, v22
v_dot2_f32_bf16 v22, v106, v10, v22
v_dot2_f32_bf16 v22, v107, v11, v22
v_add_f32_dpp v27, v27, v27 quad_perm:[1,0,3,2] row_mask:0xf bank_mask:0xf
v_add_f32_dpp v25, v23, v23 row_half_mirror row_mask:0xf bank_mask:0x5
v_add_f32_dpp v24, v21, v21 row_ror:8 row_mask:0xf bank_mask:0x3
s_waitcnt vmcnt(7)
s_cbranch_scc1 L_cf11
s_waitcnt vmcnt(6)
L_cf11:
buffer_load_dwordx4 v[104:107], v4, s[4:7], s53 offen offset:3072 nt
v_dot2_f32_bf16 v30, v168, v8, 0
v_dot2_f32_bf16 v30, v169, v9, v30
v_dot2_f32_bf16 v30, v170, v10, v30
v_dot2_f32_bf16 v30, v171, v11, v30
v_add_f32_dpp v35, v35, v35 quad_perm:[1,0,3,2] row_mask:0xf bank_mask:0xf
v_add_f32_dpp v33, v31, v31 row_half_mirror row_mask:0xf bank_mask:0x5
v_add_f32_dpp v32, v29, v29 row_ror:8 row_mask:0xf bank_mask:0x3
v_dot2_f32_bf16 v38, v232, v8, 0
v_dot2_f32_bf16 v38, v233, v9, v38
v_dot2_f32_bf16 v38, v234, v10, v38
v_dot2_f32_bf16 v38, v235, v11, v38
v_add_f32_dpp v43, v43, v43 quad_perm:[1,0,3,2] row_mask:0xf bank_mask:0xf
v_add_f32_dpp v41, v39, v39 row_half_mirror row_mask:0xf bank_mask:0x5
v_add_f32_dpp v40, v37, v37 row_ror:8 row_mask:0xf bank_mask:0x3
v_dot2_f32_bf16 v20, v108, v8, 0
v_dot2_f32_bf16 v20, v109, v9, v20
v_dot2_f32_bf16 v20, v110, v10, v20
v_dot2_f32_bf16 v20, v111, v11, v20
v_add_f32_dpp v24, v22, v22 row_ror:8 row_mask:0xf bank_mask:0xc
s_waitcnt vmcnt(7)
s_cbranch_scc1 L_cf12
s_waitcnt vmcnt(6)
L_cf12:
buffer_load_dwordx4 v[108:111], v5, s[4:7], s53 offen offset:0 nt
v_dot2_f32_bf16 v28, v172, v8, 0
v_dot2_f32_bf16 v28, v173, v9, v28
v_dot2_f32_bf16 v28, v174, v10, v28
v_dot2_f32_bf16 v28, v175, v11, v28
v_add_f32_dpp v32, v30, v30 row_ror:8 row_mask:0xf bank_mask:0xc
v_dot2_f32_bf16 v36, v236, v8, 0
v_dot2_f32_bf16 v36, v237, v9, v36
v_dot2_f32_bf16 v36, v238, v10, v36
v_dot2_f32_bf16 v36, v239, v11, v36
v_add_f32_dpp v40, v38, v38 row_ror:8 row_mask:0xf bank_mask:0xc
v_dot2_f32_bf16 v21, v112, v8, 0
v_dot2_f32_bf16 v21, v113, v9, v21
v_dot2_f32_bf16 v21, v114, v10, v21
v_dot2_f32_bf16 v21, v115, v11, v21
v_add_f32_dpp v25, v24, v24 row_half_mirror row_mask:0xf bank_mask:0xa
v_add_f32_dpp v23, v20, v20 row_ror:8 row_mask:0xf bank_mask:0x3
s_waitcnt vmcnt(7)
s_cbranch_scc1 L_cf13
s_waitcnt vmcnt(6)
L_cf13:
buffer_load_dwordx4 v[112:115], v5, s[4:7], s53 offen offset:1024 nt
v_dot2_f32_bf16 v29, v176, v8, 0
v_dot2_f32_bf16 v29, v177, v9, v29
v_dot2_f32_bf16 v29, v178, v10, v29
v_dot2_f32_bf16 v29, v179, v11, v29
v_add_f32_dpp v33, v32, v32 row_half_mirror row_mask:0xf bank_mask:0xa
v_add_f32_dpp v31, v28, v28 row_ror:8 row_mask:0xf bank_mask:0x3
v_dot2_f32_bf16 v37, v240, v8, 0
v_dot2_f32_bf16 v37, v241, v9, v37
v_dot2_f32_bf16 v37, v242, v10, v37
v_dot2_f32_bf16 v37, v243, v11, v37
v_add_f32_dpp v41, v40, v40 row_half_mirror row_mask:0xf bank_mask:0xa
v_add_f32_dpp v39, v36, v36 row_ror:8 row_mask:0xf bank_mask:0x3
v_dot2_f32_bf16 v22, v116, v8, 0
v_dot2_f32_bf16 v22, v117, v9, v22
v_dot2_f32_bf16 v22, v118, v10, v22
v_dot2_f32_bf16 v22, v119, v11, v22
v_add_f32_dpp v25, v25, v25 quad_perm:[2,3,0,1] row_mask:0xf bank_mask:0xf
v_add_f32_dpp v23, v21, v21 row_ror:8 row_mask:0xf bank_mask:0xc
s_waitcnt vmcnt(7)
s_cbranch_scc1 L_cf14
s_waitcnt vmcnt(6)
L_cf14:
buffer_load_dwordx4 v[116:119], v5, s[4:7], s53 offen offset:2048 nt
v_dot2_f32_bf16 v30, v180, v8, 0
v_dot2_f32_bf16 v30, v181, v9, v30
v_dot2_f32_bf16 v30, v182, v10, v30
v_dot2_f32_bf16 v30, v183, v11, v30
v_add_f32_dpp v33, v33, v33 quad_perm:[2,3,0,1] row_mask:0xf bank_mask:0xf
v_add_f32_dpp v31, v29, v29 row_ror:8 row_mask:0xf bank_mask:0xc
v_dot2_f32_bf16 v38, v244, v8, 0
v_dot2_f32_bf16 v38, v245, v9, v38
v_dot2_f32_bf16 v38, v246, v10, v38
v_dot2_f32_bf16 v38, v247, v11, v38
v_add_f32_dpp v41, v41, v41 quad_perm:[2,3,0,1] row_mask:0xf bank_mask:0xf
v_add_f32_dpp v39, v37, v37 row_ror:8 row_mask:0xf bank_mask:0xc
v_dot2_f32_bf16 v20, v120, v8, 0
v_dot2_f32_bf16 v20, v121, v9, v20
v_dot2_f32_bf16 v20, v122, v10, v20
v_dot2_f32_bf16 v20, v123, v11, v20
v_add_f32_dpp v26, v23, v23 row_half_mirror row_mask:0xf bank_mask:0x5
v_add_f32_dpp v24, v22, v22 row_ror:8 row_mask:0xf bank_mask:0x3
s_waitcnt vmcnt(7)
s_cbranch_scc1 L_cf15
s_waitcnt vmcnt(6)
L_cf15:
buffer_load_dwordx4 v[120:123], v5, s[4:7], s53 offen offset:3072 nt
v_dot2_f32_bf16 v28, v184, v8, 0
v_dot2_f32_bf16 v28, v185, v9, v28
v_dot2_f32_bf16 v28, v186, v10, v28
v_dot2_f32_bf16 v28, v187, v11, v28
v_add_f32_dpp v34, v31, v31 row_half_mirror row_mask:0xf bank_mask:0x5
v_add_f32_dpp v32, v30, v30 row_ror:8 row_mask:0xf bank_mask:0x3
v_dot2_f32_bf16 v36, v248, v8, 0
v_dot2_f32_bf16 v36, v249, v9, v36
v_dot2_f32_bf16 v36, v250, v10, v36
v_dot2_f32_bf16 v36, v251, v11, v36
v_add_f32_dpp v42, v39, v39 row_half_mirror row_mask:0xf bank_mask:0x5
v_add_f32_dpp v40, v38, v38 row_ror:8 row_mask:0xf bank_mask:0x3
s_nop 2
v_add_f32_dpp v24, v20, v20 row_ror:8 row_mask:0xf bank_mask:0xc
v_add_f32_dpp v32, v28, v28 row_ror:8 row_mask:0xf bank_mask:0xc
v_add_f32_dpp v40, v36, v36 row_ror:8 row_mask:0xf bank_mask:0xc
s_nop 1
v_add_f32_dpp v26, v24, v24 row_half_mirror row_mask:0xf bank_mask:0xa
v_add_f32_dpp v34, v32, v32 row_half_mirror row_mask:0xf bank_mask:0xa
v_add_f32_dpp v42, v40, v40 row_half_mirror row_mask:0xf bank_mask:0xa
s_nop 1
v_add_f32_dpp v26, v26, v26 quad_perm:[2,3,0,1] row_mask:0xf bank_mask:0xf
v_cndmask_b32 v25, v25, v26, s[60:61]
v_add_f32_dpp v34, v34, v34 quad_perm:[2,3,0,1] row_mask:0xf bank_mask:0xf
v_cndmask_b32 v33, v33, v34, s[60:61]
v_add_f32_dpp v42, v42, v42 quad_perm:[2,3,0,1] row_mask:0xf bank_mask:0xf
v_cndmask_b32 v41, v41, v42, s[60:61]
s_nop 1
v_add_f32_dpp v25, v25, v25 quad_perm:[1,0,3,2] row_mask:0xf bank_mask:0xf
v_add_f32_dpp v33, v33, v33 quad_perm:[1,0,3,2] row_mask:0xf bank_mask:0xf
v_add_f32_dpp v41, v41, v41 quad_perm:[1,0,3,2] row_mask:0xf bank_mask:0xf
v_cndmask_b32 v17, v35, v33, s[62:63]
v_cndmask_b32 v18, v43, v41, s[62:63]
v_cndmask_b32 v19, v27, v25, s[62:63]
s_add_u32 s74, s74, 1
v_mov_b32 v157, 0
v_lshrrev_b32 v20, 4, v0
v_and_b32 v24, 15, v0
v_lshlrev_b32 v136, 13, v20
v_lshl_add_u32 v136, v24, 4, v136
v_and_b32 v21, 16, v0
v_lshlrev_b32 v21, 3, v21
v_xor_b32 v136, v21, v136
v_xor_b32 v137, 32, v136
v_xor_b32 v138, 64, v136
v_xor_b32 v139, 96, v136
s_lshl_b32 s92, s43, 17
s_lshl_b32 s48, s3, 8
s_add_u32 s92, s92, s48
s_lshl_b32 s48, s42, 15
s_add_u32 s92, s92, s48
s_add_u32 s93, s92, 4096
s_lshl_b32 s49, s42, 13
s_add_u32 m0, s49, 16384
s_cmp_eq_u32 s51, 0
s_cbranch_scc0 L_nc3o
L_nc3:
s_mov_b32 s4, s30
s_mov_b32 s5, s31
s_lshl_b32 s47, s66, 13
s_add_u32 s53, s72, s47
s_add_u32 s53, s53, 1572864
L_kbody:
s_bitcmp1_b64 s[56:57], s54
s_cselect_b32 s65, 1, 0
s_cbranch_scc0 L_ntk
s_mov_b32 s59, 1
s_atomic_add s59, s[40:41], s58 glc
L_ntk:
s_cmp_ge_u32 s54, 39
s_cselect_b32 s50, 3, s50
s_bitcmp0_b32 s50, 0
s_cselect_b64 vcc, -1, 0
s_bitcmp1_b32 s50, 1
v_dot2_f32_bf16 v20, v60, v8, 0
v_dot2_f32_bf16 v20, v61, v9, v20
v_dot2_f32_bf16 v20, v62, v10, v20
v_dot2_f32_bf16 v20, v63, v11, v20
v_mov_b32 v12, v13
s_waitcnt vmcnt(6)
s_cbranch_scc1 L_gok0
s_waitcnt vmcnt(5)
s_cbranch_vccz L_gok0
s_waitcnt vmcnt(4)
s_cmp_eq_u32 s50, 4
s_cbranch_scc0 L_gok0
s_waitcnt vmcnt(3)
s_cmp_eq_u32 s50, 0
L_gok0:
buffer_load_dwordx4 v[60:63], v2, s[4:7], s53 offen offset:0 nt
v_dot2_f32_bf16 v21, v64, v8, 0
v_dot2_f32_bf16 v21, v65, v9, v21
v_dot2_f32_bf16 v21, v66, v10, v21
v_dot2_f32_bf16 v21, v67, v11, v21
v_add_f32_dpp v23, v20, v20 row_ror:8 row_mask:0xf bank_mask:0x3
v_mov_b32 v13, v14
s_waitcnt vmcnt(6)
s_cbranch_scc1 L_gok1
s_waitcnt vmcnt(5)
s_cbranch_vccz L_gok1
s_waitcnt vmcnt(4)
L_gok1:
buffer_load_dwordx4 v[64:67], v2, s[4:7], s53 offen offset:1024 nt
v_dot2_f32_bf16 v22, v68, v8, 0
v_dot2_f32_bf16 v22, v69, v9, v22
v_dot2_f32_bf16 v22, v70, v10, v22
v_dot2_f32_bf16 v22, v71, v11, v22
v_add_f32_dpp v23, v21, v21 row_ror:8 row_mask:0xf bank_mask:0xc
v_mov_b32 v14, v15
s_waitcnt vmcnt(6)
s_cbranch_scc1 L_gok2
s_waitcnt vmcnt(5)
s_cbranch_vccz L_gok2
s_waitcnt vmcnt(4)
s_cmp_eq_u32 s50, 4
s_cbranch_scc0 L_gok2
s_waitcnt vmcnt(3)
s_cmp_eq_u32 s50, 0
L_gok2:
buffer_load_dwordx4 v[68:71], v2, s[4:7], s53 offen offset:2048 nt
v_dot2_f32_bf16 v20, v72, v8, 0
v_dot2_f32_bf16 v20, v73, v9, v20
v_dot2_f32_bf16 v20, v74, v10, v20
v_dot2_f32_bf16 v20, v75, v11, v20
v_add_f32_dpp v25, v23, v23 row_half_mirror row_mask:0xf bank_mask:0x5
v_add_f32_dpp v24, v22, v22 row_ror:8 row_mask:0xf bank_mask:0x3
v_mov_b32 v15, v16
s_waitcnt vmcnt(6)
s_cbranch_scc1 L_gok3
s_waitcnt vmcnt(5)
s_cbranch_vccz L_gok3
s_waitcnt vmcnt(4)
L_gok3:
buffer_load_dwordx4 v[72:75], v2, s[4:7], s53 offen offset:3072 nt
v_dot2_f32_bf16 v21, v76, v8, 0
v_dot2_f32_bf16 v21, v77, v9, v21
v_dot2_f32_bf16 v21, v78, v10, v21
v_dot2_f32_bf16 v21, v79, v11, v21
v_add_f32_dpp v24, v20, v20 row_ror:8 row_mask:0xf bank_mask:0xc
v_mov_b32 v16, v17
s_waitcnt vmcnt(6)
s_cbranch_scc1 L_gok4
s_waitcnt vmcnt(5)
s_cbranch_vccz L_gok4
s_waitcnt vmcnt(4)
s_cmp_eq_u32 s50, 4
s_cbranch_scc0 L_gok4
s_waitcnt vmcnt(3)
s_cmp_eq_u32 s50, 0
L_gok4:
buffer_load_dwordx4 v[76:79], v3, s[4:7], s53 offen offset:0 nt
v_dot2_f32_bf16 v22, v80, v8, 0
v_dot2_f32_bf16 v22, v81, v9, v22
v_dot2_f32_bf16 v22, v82, v10, v22
v_dot2_f32_bf16 v22, v83, v11, v22
v_add_f32_dpp v25, v24, v24 row_half_mirror row_mask:0xf bank_mask:0xa
v_add_f32_dpp v23, v21, v21 row_ror:8 row_mask:0xf bank_mask:0x3
v_mov_b32 v17, v18
s_waitcnt vmcnt(6)
s_cbranch_scc1 L_gok5
s_waitcnt vmcnt(5)
s_cbranch_vccz L_gok5
s_waitcnt vmcnt(4)
L_gok5:
buffer_load_dwordx4 v[80:83], v3, s[4:7], s53 offen offset:1024 nt
v_dot2_f32_bf16 v20, v84, v8, 0
v_dot2_f32_bf16 v20, v85, v9, v20
v_dot2_f32_bf16 v20, v86, v10, v20
v_dot2_f32_bf16 v20, v87, v11, v20
v_add_f32_dpp v25, v25, v25 quad_perm:[2,3,0,1] row_mask:0xf bank_mask:0xf
v_add_f32_dpp v23, v22, v22 row_ror:8 row_mask:0xf bank_mask:0xc
v_mov_b32 v18, v19
s_waitcnt vmcnt(6)
s_cbranch_scc1 L_gok6
s_waitcnt vmcnt(5)
s_cbranch_vccz L_gok6
s_waitcnt vmcnt(4)
s_cmp_eq_u32 s50, 4
s_cbranch_scc0 L_gok6
s_waitcnt vmcnt(3)
s_cmp_eq_u32 s50, 0
L_gok6:
buffer_load_dwordx4 v[84:87], v3, s[4:7], s53 offen offset:2048 nt
v_dot2_f32_bf16 v21, v88, v8, 0
v_dot2_f32_bf16 v21, v89, v9, v21
v_dot2_f32_bf16 v21, v90, v10, v21
v_dot2_f32_bf16 v21, v91, v11, v21
v_add_f32_dpp v26, v23, v23 row_half_mirror row_mask:0xf bank_mask:0x5
v_add_f32_dpp v24, v20, v20 row_ror:8 row_mask:0xf bank_mask:0x3
s_cmp_eq_u32 s65, 0
s_cbranch_scc1 L_nuk
s_waitcnt lgkmcnt(0)
s_mul_i32 s47, s44, 768
s_add_u32 s47, s47, s58
s_and_b32 s47, s47, 0x1f00
s_andn2_b32 s58, s58, 0x1f00
s_or_b32 s58, s58, s47
s_add_u32 s58, s58, 8192
s_cmp_ge_u32 s59, 3
s_cselect_b32 s47, 4, 0
s_cmp_ge_u32 s59, 6
s_cselect_b32 s47, 8, s47
s_lshr_b32 s47, s68, s47
s_and_b32 s47, s47, 7
v_mov_b32 v156, s47
ds_write_b32 v157, v156 offset:516
L_nuk:
s_bitcmp1_b32 s50, 1
s_waitcnt vmcnt(6)
s_cbranch_scc1 L_gok7
s_waitcnt vmcnt(5)
s_cbranch_vccz L_gok7
s_waitcnt vmcnt(4)
L_gok7:
buffer_load_dwordx4 v[88:91], v3, s[4:7], s53 offen offset:3072 nt
v_dot2_f32_bf16 v22, v92, v8, 0
v_dot2_f32_bf16 v22, v93, v9, v22
v_dot2_f32_bf16 v22, v94, v10, v22
v_dot2_f32_bf16 v22, v95, v11, v22
v_add_f32_dpp v24, v21, v21 row_ror:8 row_mask:0xf bank_mask:0xc
s_waitcnt vmcnt(6)
s_cbranch_scc1 L_gok8
s_waitcnt vmcnt(5)
s_cbranch_vccz L_gok8
s_waitcnt vmcnt(4)
s_cmp_eq_u32 s50, 4
s_cbranch_scc0 L_gok8
s_waitcnt vmcnt(3)
s_cmp_eq_u32 s50, 0
L_gok8:
buffer_load_dwordx4 v[92:95], v4, s[4:7], s53 offen offset:0 nt
v_dot2_f32_bf16 v20, v96, v8, 0
v_dot2_f32_bf16 v20, v97, v9, v20
v_dot2_f32_bf16 v20, v98, v10, v20
v_dot2_f32_bf16 v20, v99, v11, v20
v_add_f32_dpp v26, v24, v24 row_half_mirror row_mask:0xf bank_mask:0xa
v_add_f32_dpp v23, v22, v22 row_ror:8 row_mask:0xf bank_mask:0x3
ds_read_b32 v156, v157 offset:516
s_waitcnt vmcnt(6)
s_cbranch_scc1 L_gok9
s_waitcnt vmcnt(5)
s_cbranch_vccz L_gok9
s_waitcnt vmcnt(4)
L_gok9:
buffer_load_dwordx4 v[96:99], v4, s[4:7], s53 offen offset:1024 nt
v_dot2_f32_bf16 v21, v100, v8, 0
v_dot2_f32_bf16 v21, v101, v9, v21
v_dot2_f32_bf16 v21, v102, v10, v21
v_dot2_f32_bf16 v21, v103, v11, v21
v_add_f32_dpp v26, v26, v26 quad_perm:[2,3,0,1] row_mask:0xf bank_mask:0xf
v_cndmask_b32 v27, v25, v26, s[60:61]
v_add_f32_dpp v23, v20, v20 row_ror:8 row_mask:0xf bank_mask:0xc
s_waitcnt lgkmcnt(0)
v_readfirstlane_b32 s50, v156
s_cmp_ge_u32 s54, 39
s_cselect_b32 s50, 3, s50
s_bitcmp0_b32 s50, 0
s_cselect_b64 vcc, -1, 0
s_bitcmp1_b32 s50, 1
s_waitcnt vmcnt(6)
s_cbranch_scc1 L_gok10
s_waitcnt vmcnt(5)
s_cbranch_vccz L_gok10
s_waitcnt vmcnt(4)
s_cmp_eq_u32 s50, 4
s_cbranch_scc0 L_gok10
s_waitcnt vmcnt(3)
s_cmp_eq_u32 s50, 0
L_gok10:
buffer_load_dwordx4 v[100:103], v4, s[4:7], s53 offen offset:2048 nt
v_dot2_f32_bf16 v22, v104, v8, 0
v_dot2_f32_bf16 v22, v105, v9, v22
v_dot2_f32_bf16 v22, v106, v10, v22
v_dot2_f32_bf16 v22, v107, v11, v22
v_add_f32_dpp v27, v27, v27 quad_perm:[1,0,3,2] row_mask:0xf bank_mask:0xf
v_add_f32_dpp v25, v23, v23 row_half_mirror row_mask:0xf bank_mask:0x5
v_add_f32_dpp v24, v21, v21 row_ror:8 row_mask:0xf bank_mask:0x3
s_waitcnt vmcnt(6)
s_cbranch_scc1 L_gok11
s_waitcnt vmcnt(5)
s_cbranch_vccz L_gok11
s_waitcnt vmcnt(4)
L_gok11:
buffer_load_dwordx4 v[104:107], v4, s[4:7], s53 offen offset:3072 nt
v_dot2_f32_bf16 v20, v108, v8, 0
v_dot2_f32_bf16 v20, v109, v9, v20
v_dot2_f32_bf16 v20, v110, v10, v20
v_dot2_f32_bf16 v20, v111, v11, v20
v_add_f32_dpp v24, v22, v22 row_ror:8 row_mask:0xf bank_mask:0xc
s_waitcnt vmcnt(6)
s_cbranch_scc1 L_gok12
s_waitcnt vmcnt(5)
s_cbranch_vccz L_gok12
s_waitcnt vmcnt(4)
s_cmp_eq_u32 s50, 4
s_cbranch_scc0 L_gok12
s_waitcnt vmcnt(3)
s_cmp_eq_u32 s50, 0
L_gok12:
buffer_load_dwordx4 v[108:111], v5, s[4:7], s53 offen offset:0 nt
v_dot2_f32_bf16 v21, v112, v8, 0
v_dot2_f32_bf16 v21, v113, v9, v21
v_dot2_f32_bf16 v21, v114, v10, v21
v_dot2_f32_bf16 v21, v115, v11, v21
v_add_f32_dpp v25, v24, v24 row_half_mirror row_mask:0xf bank_mask:0xa
v_add_f32_dpp v23, v20, v20 row_ror:8 row_mask:0xf bank_mask:0x3
s_waitcnt vmcnt(6)
s_cbranch_scc1 L_gok13
s_waitcnt vmcnt(5)
s_cbranch_vccz L_gok13
s_waitcnt vmcnt(4)
L_gok13:
buffer_load_dwordx4 v[112:115], v5, s[4:7], s53 offen offset:1024 nt
v_dot2_f32_bf16 v22, v116, v8, 0
v_dot2_f32_bf16 v22, v117, v9, v22
v_dot2_f32_bf16 v22, v118, v10, v22
v_dot2_f32_bf16 v22, v119, v11, v22
v_add_f32_dpp v25, v25, v25 quad_perm:[2,3,0,1] row_mask:0xf bank_mask:0xf
v_add_f32_dpp v23, v21, v21 row_ror:8 row_mask:0xf bank_mask:0xc
s_bitcmp1_b64 s[86:87], s54
s_cselect_b64 vcc, 0, vcc
s_cselect_b32 s47, 3, s50
s_bitcmp1_b32 s47, 1
s_waitcnt vmcnt(14)
s_cbranch_scc0 L_lok14
s_cbranch_vccz L_gok14
L_lok14:
s_waitcnt vmcnt(6)
s_cbranch_scc1 L_gok14
s_waitcnt vmcnt(5)
s_cbranch_vccz L_gok14
s_waitcnt vmcnt(4)
s_cmp_eq_u32 s50, 4
s_cbranch_scc0 L_gok14
s_waitcnt vmcnt(3)
s_cmp_eq_u32 s50, 0
L_gok14:
buffer_load_dwordx4 v[116:119], v5, s[4:7], s53 offen offset:2048 nt
v_dot2_f32_bf16 v20, v120, v8, 0
v_dot2_f32_bf16 v20, v121, v9, v20
v_dot2_f32_bf16 v20, v122, v10, v20
v_dot2_f32_bf16 v20, v123, v11, v20
v_add_f32_dpp v26, v23, v23 row_half_mirror row_mask:0xf bank_mask:0x5
v_add_f32_dpp v24, v22, v22 row_ror:8 row_mask:0xf bank_mask:0x3
s_waitcnt vmcnt(14)
s_cbranch_scc0 L_lok15
s_cbranch_vccz L_gok15
L_lok15:
s_waitcnt vmcnt(6)
s_cbranch_scc1 L_gok15
s_waitcnt vmcnt(5)
s_cbranch_vccz L_gok15
s_waitcnt vmcnt(4)
L_gok15:
buffer_load_dwordx4 v[120:123], v5, s[4:7], s53 offen offset:3072 nt
s_nop 2
v_add_f32_dpp v24, v20, v20 row_ror:8 row_mask:0xf bank_mask:0xc
s_nop 1
v_add_f32_dpp v26, v24, v24 row_half_mirror row_mask:0xf bank_mask:0xa
s_nop 1
v_add_f32_dpp v26, v26, v26 quad_perm:[2,3,0,1] row_mask:0xf bank_mask:0xf
v_cndmask_b32 v25, v25, v26, s[60:61]
s_nop 1
v_add_f32_dpp v25, v25, v25 quad_perm:[1,0,3,2] row_mask:0xf bank_mask:0xf
v_cndmask_b32 v19, v27, v25, s[62:63]
s_bitcmp1_b64 s[70:71], s54
s_cbranch_scc1 L_hooks
s_add_u32 s53, s53, 0x20000
s_add_u32 s54, s54, 1
s_branch L_kbody
L_pad0:
s_branch L_pad4
L_vbody:
v_and_b32 v7, 0xffff, v56
v_lshl_or_b32 v7, v7, 16, v7
v_alignbit_b32 v56, v57, v56, 16
v_alignbit_b32 v57, v58, v57, 16
v_alignbit_b32 v58, v59, v58, 16
v_lshrrev_b32 v59, 16, v59
s_bitcmp1_b64 s[56:57], s54
s_cselect_b32 s65, 1, 0
s_cbranch_scc0 L_ntv
s_mov_b32 s59, 1
s_atomic_add s59, s[40:41], s58 glc
L_ntv:
s_cmp_ge_u32 s54, 39
s_cselect_b32 s50, 3, s50
s_bitcmp0_b32 s50, 0
s_cselect_b64 vcc, -1, 0
s_bitcmp1_b32 s50, 1
v_and_b32_dpp v12, v7, v44 row_newbcast:0 row_mask:0xf bank_mask:0xf
v_and_b32_dpp v13, v7, v45 row_newbcast:0 row_mask:0xf bank_mask:0xf
v_and_b32_dpp v14, v7, v46 row_newbcast:0 row_mask:0xf bank_mask:0xf
v_and_b32_dpp v15, v7, v47 row_newbcast:0 row_mask:0xf bank_mask:0xf
v_and_b32_dpp v16, v7, v44 row_newbcast:8 row_mask:0xf bank_mask:0xf
v_and_b32_dpp v17, v7, v45 row_newbcast:8 row_mask:0xf bank_mask:0xf
v_and_b32_dpp v18, v7, v46 row_newbcast:8 row_mask:0xf bank_mask:0xf
v_and_b32_dpp v19, v7, v47 row_newbcast:8 row_mask:0xf bank_mask:0xf
v_mfma_f32_16x16x32_bf16 v[48:51], v[12:15], v[60:63], v[48:51]
s_waitcnt vmcnt(14)
s_cbranch_scc0 L_lov0
s_cbranch_vccz L_gov0
L_lov0:
s_waitcnt vmcnt(5)
s_cbranch_scc1 L_gov0
s_waitcnt vmcnt(4)
s_cbranch_vccz L_gov0
s_cmp_eq_u32 s50, 4
s_cbranch_scc0 L_gov0
s_waitcnt vmcnt(3)
s_cmp_eq_u32 s50, 0
L_gov0:
buffer_load_dwordx4 v[60:63], v2, s[4:7], s53 offen offset:0 nt
v_and_b32_dpp v12, v7, v44 row_newbcast:4 row_mask:0xf bank_mask:0xf
v_and_b32_dpp v13, v7, v45 row_newbcast:4 row_mask:0xf bank_mask:0xf
v_and_b32_dpp v14, v7, v46 row_newbcast:4 row_mask:0xf bank_mask:0xf
v_and_b32_dpp v15, v7, v47 row_newbcast:4 row_mask:0xf bank_mask:0xf
v_mfma_f32_16x16x32_bf16 v[48:51], v[16:19], v[64:67], v[48:51]
s_waitcnt vmcnt(14)
s_cbranch_scc0 L_lov1
s_cbranch_vccz L_gov1
L_lov1:
s_waitcnt vmcnt(6)
s_cbranch_scc1 L_gov1
s_waitcnt vmcnt(5)
s_cbranch_vccz L_gov1
s_waitcnt vmcnt(4)
L_gov1:
buffer_load_dwordx4 v[64:67], v2, s[4:7], s53 offen offset:1024 nt
v_and_b32_dpp v16, v7, v44 row_newbcast:12 row_mask:0xf bank_mask:0xf
v_and_b32_dpp v17, v7, v45 row_newbcast:12 row_mask:0xf bank_mask:0xf
v_and_b32_dpp v18, v7, v46 row_newbcast:12 row_mask:0xf bank_mask:0xf
v_and_b32_dpp v19, v7, v47 row_newbcast:12 row_mask:0xf bank_mask:0xf
v_mfma_f32_16x16x32_bf16 v[48:51], v[12:15], v[68:71], v[48:51]
s_waitcnt vmcnt(14)
s_cbranch_scc0 L_lov2
s_cbranch_vccz L_gov2
L_lov2:
s_waitcnt vmcnt(5)
s_cbranch_scc1 L_gov2
s_waitcnt vmcnt(4)
s_cbranch_vccz L_gov2
s_cmp_eq_u32 s50, 4
s_cbranch_scc0 L_gov2
s_waitcnt vmcnt(3)
s_cmp_eq_u32 s50, 0
L_gov2:
buffer_load_dwordx4 v[68:71], v2, s[4:7], s53 offen offset:2048 nt
v_and_b32_dpp v12, v7, v44 row_newbcast:2 row_mask:0xf bank_mask:0xf
v_and_b32_dpp v13, v7, v45 row_newbcast:2 row_mask:0xf bank_mask:0xf
v_and_b32_dpp v14, v7, v46 row_newbcast:2 row_mask:0xf bank_mask:0xf
v_and_b32_dpp v15, v7, v47 row_newbcast:2 row_mask:0xf bank_mask:0xf
v_mfma_f32_16x16x32_bf16 v[48:51], v[16:19], v[72:75], v[48:51]
s_waitcnt vmcnt(14)
s_cbranch_scc0 L_lov3
s_cbranch_vccz L_gov3
L_lov3:
s_waitcnt vmcnt(6)
s_cbranch_scc1 L_gov3
s_waitcnt vmcnt(5)
s_cbranch_vccz L_gov3
s_waitcnt vmcnt(4)
L_gov3:
buffer_load_dwordx4 v[72:75], v2, s[4:7], s53 offen offset:3072 nt
v_and_b32_dpp v16, v7, v44 row_newbcast:10 row_mask:0xf bank_mask:0xf
v_and_b32_dpp v17, v7, v45 row_newbcast:10 row_mask:0xf bank_mask:0xf
v_and_b32_dpp v18, v7, v46 row_newbcast:10 row_mask:0xf bank_mask:0xf
v_and_b32_dpp v19, v7, v47 row_newbcast:10 row_mask:0xf bank_mask:0xf
v_mfma_f32_16x16x32_bf16 v[48:51], v[12:15], v[76:79], v[48:51]
s_waitcnt vmcnt(14)
s_cbranch_scc0 L_lov4
s_cbranch_vccz L_gov4
L_lov4:
s_waitcnt vmcnt(5)
s_cbranch_scc1 L_gov4
s_waitcnt vmcnt(4)
s_cbranch_vccz L_gov4
s_cmp_eq_u32 s50, 4
s_cbranch_scc0 L_gov4
s_waitcnt vmcnt(3)
s_cmp_eq_u32 s50, 0
L_gov4:
buffer_load_dwordx4 v[76:79], v3, s[4:7], s53 offen offset:0 nt
v_and_b32_dpp v12, v7, v44 row_newbcast:6 row_mask:0xf bank_mask:0xf
v_and_b32_dpp v13, v7, v45 row_newbcast:6 row_mask:0xf bank_mask:0xf
v_and_b32_dpp v14, v7, v46 row_newbcast:6 row_mask:0xf bank_mask:0xf
v_and_b32_dpp v15, v7, v47 row_newbcast:6 row_mask:0xf bank_mask:0xf
v_mfma_f32_16x16x32_bf16 v[48:51], v[16:19], v[80:83], v[48:51]
s_waitcnt vmcnt(14)
s_cbranch_scc0 L_lov5
s_cbranch_vccz L_gov5
L_lov5:
s_waitcnt vmcnt(6)
s_cbranch_scc1 L_gov5
s_waitcnt vmcnt(5)
s_cbranch_vccz L_gov5
s_waitcnt vmcnt(4)
L_gov5:
buffer_load_dwordx4 v[80:83], v3, s[4:7], s53 offen offset:1024 nt
v_and_b32_dpp v16, v7, v44 row_newbcast:14 row_mask:0xf bank_mask:0xf
v_and_b32_dpp v17, v7, v45 row_newbcast:14 row_mask:0xf bank_mask:0xf
v_and_b32_dpp v18, v7, v46 row_newbcast:14 row_mask:0xf bank_mask:0xf
v_and_b32_dpp v19, v7, v47 row_newbcast:14 row_mask:0xf bank_mask:0xf
v_mfma_f32_16x16x32_bf16 v[48:51], v[12:15], v[84:87], v[48:51]
s_waitcnt vmcnt(14)
s_cbranch_scc0 L_lov6
s_cbranch_vccz L_gov6
L_lov6:
s_waitcnt vmcnt(5)
s_cbranch_scc1 L_gov6
s_waitcnt vmcnt(4)
s_cbranch_vccz L_gov6
s_cmp_eq_u32 s50, 4
s_cbranch_scc0 L_gov6
s_waitcnt vmcnt(3)
s_cmp_eq_u32 s50, 0
L_gov6:
buffer_load_dwordx4 v[84:87], v3, s[4:7], s53 offen offset:2048 nt
v_and_b32_dpp v12, v7, v44 row_newbcast:1 row_mask:0xf bank_mask:0xf
v_and_b32_dpp v13, v7, v45 row_newbcast:1 row_mask:0xf bank_mask:0xf
v_and_b32_dpp v14, v7, v46 row_newbcast:1 row_mask:0xf bank_mask:0xf
v_and_b32_dpp v15, v7, v47 row_newbcast:1 row_mask:0xf bank_mask:0xf
v_mfma_f32_16x16x32_bf16 v[48:51], v[16:19], v[88:91], v[48:51]
s_cmp_eq_u32 s65, 0
s_cbranch_scc1 L_nuv
s_waitcnt lgkmcnt(0)
s_mul_i32 s47, s44, 768
s_add_u32 s47, s47, s58
s_and_b32 s47, s47, 0x1f00
s_andn2_b32 s58, s58, 0x1f00
s_or_b32 s58, s58, s47
s_add_u32 s58, s58, 8192
s_cmp_ge_u32 s59, 3
s_cselect_b32 s47, 4, 0
s_cmp_ge_u32 s59, 6
s_cselect_b32 s47, 8, s47
s_lshr_b32 s47, s68, s47
s_and_b32 s47, s47, 7
v_mov_b32 v156, s47
ds_write_b32 v157, v156 offset:516
L_nuv:
s_bitcmp1_b32 s50, 1
s_waitcnt vmcnt(14)
s_cbranch_scc0 L_lov7
s_cbranch_vccz L_gov7
L_lov7:
s_waitcnt vmcnt(6)
s_cbranch_scc1 L_gov7
s_waitcnt vmcnt(5)
s_cbranch_vccz L_gov7
s_waitcnt vmcnt(4)
L_gov7:
buffer_load_dwordx4 v[88:91], v3, s[4:7], s53 offen offset:3072 nt
v_and_b32_dpp v16, v7, v44 row_newbcast:9 row_mask:0xf bank_mask:0xf
v_and_b32_dpp v17, v7, v45 row_newbcast:9 row_mask:0xf bank_mask:0xf
v_and_b32_dpp v18, v7, v46 row_newbcast:9 row_mask:0xf bank_mask:0xf
v_and_b32_dpp v19, v7, v47 row_newbcast:9 row_mask:0xf bank_mask:0xf
v_mfma_f32_16x16x32_bf16 v[48:51], v[12:15], v[92:95], v[48:51]
s_waitcnt vmcnt(14)
s_cbranch_scc0 L_lov8
s_cbranch_vccz L_gov8
L_lov8:
s_waitcnt vmcnt(5)
s_cbranch_scc1 L_gov8
s_waitcnt vmcnt(4)
s_cbranch_vccz L_gov8
s_cmp_eq_u32 s50, 4
s_cbranch_scc0 L_gov8
s_waitcnt vmcnt(3)
s_cmp_eq_u32 s50, 0
L_gov8:
buffer_load_dwordx4 v[92:95], v4, s[4:7], s53 offen offset:0 nt
v_and_b32_dpp v12, v7, v44 row_newbcast:5 row_mask:0xf bank_mask:0xf
v_and_b32_dpp v13, v7, v45 row_newbcast:5 row_mask:0xf bank_mask:0xf
v_and_b32_dpp v14, v7, v46 row_newbcast:5 row_mask:0xf bank_mask:0xf
v_and_b32_dpp v15, v7, v47 row_newbcast:5 row_mask:0xf bank_mask:0xf
v_mfma_f32_16x16x32_bf16 v[48:51], v[16:19], v[96:99], v[48:51]
ds_read_b32 v156, v157 offset:516
s_waitcnt vmcnt(14)
s_cbranch_scc0 L_lov9
s_cbranch_vccz L_gov9
L_lov9:
s_waitcnt vmcnt(6)
s_cbranch_scc1 L_gov9
s_waitcnt vmcnt(5)
s_cbranch_vccz L_gov9
s_waitcnt vmcnt(4)
L_gov9:
buffer_load_dwordx4 v[96:99], v4, s[4:7], s53 offen offset:1024 nt
v_and_b32_dpp v16, v7, v44 row_newbcast:13 row_mask:0xf bank_mask:0xf
v_and_b32_dpp v17, v7, v45 row_newbcast:13 row_mask:0xf bank_mask:0xf
v_and_b32_dpp v18, v7, v46 row_newbcast:13 row_mask:0xf bank_mask:0xf
v_and_b32_dpp v19, v7, v47 row_newbcast:13 row_mask:0xf bank_mask:0xf
v_mfma_f32_16x16x32_bf16 v[48:51], v[12:15], v[100:103], v[48:51]
s_waitcnt lgkmcnt(0)
v_readfirstlane_b32 s50, v156
s_cmp_ge_u32 s54, 39
s_cselect_b32 s50, 3, s50
s_bitcmp0_b32 s50, 0
s_cselect_b64 vcc, -1, 0
s_bitcmp1_b32 s50, 1
s_waitcnt vmcnt(14)
s_cbranch_scc0 L_lov10
s_cbranch_vccz L_gov10
L_lov10:
s_waitcnt vmcnt(5)
s_cbranch_scc1 L_gov10
s_waitcnt vmcnt(4)
s_cbranch_vccz L_gov10
s_cmp_eq_u32 s50, 4
s_cbranch_scc0 L_gov10
s_waitcnt vmcnt(3)
s_cmp_eq_u32 s50, 0
L_gov10:
buffer_load_dwordx4 v[100:103], v4, s[4:7], s53 offen offset:2048 nt
v_and_b32_dpp v12, v7, v44 row_newbcast:3 row_mask:0xf bank_mask:0xf
v_and_b32_dpp v13, v7, v45 row_newbcast:3 row_mask:0xf bank_mask:0xf
v_and_b32_dpp v14, v7, v46 row_newbcast:3 row_mask:0xf bank_mask:0xf
v_and_b32_dpp v15, v7, v47 row_newbcast:3 row_mask:0xf bank_mask:0xf
v_mfma_f32_16x16x32_bf16 v[48:51], v[16:19], v[104:107], v[48:51]
s_waitcnt vmcnt(14)
s_cbranch_scc0 L_lov11
s_cbranch_vccz L_gov11
L_lov11:
s_waitcnt vmcnt(6)
s_cbranch_scc1 L_gov11
s_waitcnt vmcnt(5)
s_cbranch_vccz L_gov11
s_waitcnt vmcnt(4)
L_gov11:
buffer_load_dwordx4 v[104:107], v4, s[4:7], s53 offen offset:3072 nt
v_and_b32_dpp v16, v7, v44 row_newbcast:11 row_mask:0xf bank_mask:0xf
v_and_b32_dpp v17, v7, v45 row_newbcast:11 row_mask:0xf bank_mask:0xf
v_and_b32_dpp v18, v7, v46 row_newbcast:11 row_mask:0xf bank_mask:0xf
v_and_b32_dpp v19, v7, v47 row_newbcast:11 row_mask:0xf bank_mask:0xf
v_mfma_f32_16x16x32_bf16 v[48:51], v[12:15], v[108:111], v[48:51]
s_waitcnt vmcnt(14)
s_cbranch_scc0 L_lov12
s_cbranch_vccz L_gov12
L_lov12:
s_waitcnt vmcnt(5)
s_cbranch_scc1 L_gov12
s_waitcnt vmcnt(4)
s_cbranch_vccz L_gov12
s_cmp_eq_u32 s50, 4
s_cbranch_scc0 L_gov12
s_waitcnt vmcnt(3)
s_cmp_eq_u32 s50, 0
L_gov12:
buffer_load_dwordx4 v[108:111], v5, s[4:7], s53 offen offset:0 nt
v_and_b32_dpp v12, v7, v44 row_newbcast:7 row_mask:0xf bank_mask:0xf
v_and_b32_dpp v13, v7, v45 row_newbcast:7 row_mask:0xf bank_mask:0xf
v_and_b32_dpp v14, v7, v46 row_newbcast:7 row_mask:0xf bank_mask:0xf
v_and_b32_dpp v15, v7, v47 row_newbcast:7 row_mask:0xf bank_mask:0xf
v_mfma_f32_16x16x32_bf16 v[48:51], v[16:19], v[112:115], v[48:51]
s_waitcnt vmcnt(14)
s_cbranch_scc0 L_lov13
s_cbranch_vccz L_gov13
L_lov13:
s_waitcnt vmcnt(6)
s_cbranch_scc1 L_gov13
s_waitcnt vmcnt(5)
s_cbranch_vccz L_gov13
s_waitcnt vmcnt(4)
L_gov13:
buffer_load_dwordx4 v[112:115], v5, s[4:7], s53 offen offset:1024 nt
v_and_b32_dpp v16, v7, v44 row_newbcast:15 row_mask:0xf bank_mask:0xf
v_and_b32_dpp v17, v7, v45 row_newbcast:15 row_mask:0xf bank_mask:0xf
v_and_b32_dpp v18, v7, v46 row_newbcast:15 row_mask:0xf bank_mask:0xf
v_and_b32_dpp v19, v7, v47 row_newbcast:15 row_mask:0xf bank_mask:0xf
v_mfma_f32_16x16x32_bf16 v[48:51], v[12:15], v[116:119], v[48:51]
s_waitcnt vmcnt(14)
s_cbranch_scc0 L_lov14
s_cbranch_vccz L_gov14
L_lov14:
s_waitcnt vmcnt(5)
s_cbranch_scc1 L_gov14
s_waitcnt vmcnt(4)
s_cbranch_vccz L_gov14
s_cmp_eq_u32 s50, 4
s_cbranch_scc0 L_gov14
s_waitcnt vmcnt(3)
s_cmp_eq_u32 s50, 0
L_gov14:
buffer_load_dwordx4 v[116:119], v5, s[4:7], s53 offen offset:2048 nt
v_mfma_f32_16x16x32_bf16 v[48:51], v[16:19], v[120:123], v[48:51]
s_waitcnt vmcnt(14)
s_cbranch_scc0 L_lov15
s_cbranch_vccz L_gov15
L_lov15:
s_waitcnt vmcnt(6)
s_cbranch_scc1 L_gov15
s_waitcnt vmcnt(5)
s_cbranch_vccz L_gov15
s_waitcnt vmcnt(4)
L_gov15:
buffer_load_dwordx4 v[120:123], v5, s[4:7], s53 offen offset:3072 nt
s_bitcmp1_b64 s[70:71], s54
s_cbranch_scc1 L_hooks
s_add_u32 s53, s53, 0x20000
s_add_u32 s54, s54, 1
s_branch L_vbody
L_pad1:
s_branch L_pad5
L_hooks:
s_cmp_eq_u32 s54, 40
s_cbranch_scc1 L_sfin
s_cmp_eq_u32 s54, 39
s_cbranch_scc1 L_h39
s_cmp_eq_u32 s54, 7
s_cbranch_scc1 L_h7
s_cmp_eq_u32 s54, 8
s_cbranch_scc1 L_h8
s_cmp_eq_u32 s54, 23
s_cbranch_scc1 L_h23
s_cmp_eq_u32 s54, 32
s_cbranch_scc1 L_h32
s_cmp_eq_u32 s54, 36
s_cbranch_scc1 L_h36
s_cmp_eq_u32 s54, 22
s_cbranch_scc1 L_h22
s_cmp_eq_u32 s54, 30
s_cbranch_scc1 L_h30
s_cmp_eq_u32 s54, 31
s_cbranch_scc1 L_h31
v_mov_b32 v56, v124
v_mov_b32 v57, v125
v_mov_b32 v58, v126
v_mov_b32 v59, v127
v_max3_f32 v20, v12, v13, v14
v_max3_f32 v21, v15, v16, v17
v_max3_f32 v20, v20, v18, v19
v_max_f32 v20, v20, v21
s_nop 1
v_max_f32_dpp v20, v20, v20 quad_perm:[1,0,3,2] row_mask:0xf bank_mask:0xf
s_nop 1
v_max_f32_dpp v20, v20, v20 quad_perm:[2,3,0,1] row_mask:0xf bank_mask:0xf
s_nop 1
v_max_f32_dpp v20, v20, v20 row_half_mirror row_mask:0xf bank_mask:0xf
s_nop 1
v_max_f32_dpp v20, v20, v20 row_mirror row_mask:0xf bank_mask:0xf
v_mov_b32 v21, v20
s_nop 1
v_permlane16_swap_b32 v21, v20
s_nop 1
v_max_f32 v20, v20, v21
v_mov_b32 v21, v20
s_nop 1
v_permlane32_swap_b32 v21, v20
s_nop 1
v_max_f32 v20, v20, v21
v_mul_f32 v22, s64, v20
v_fma_f32 v12, v12, s64, -v22
v_fma_f32 v13, v13, s64, -v22
v_fma_f32 v14, v14, s64, -v22
v_fma_f32 v15, v15, s64, -v22
v_fma_f32 v16, v16, s64, -v22
v_fma_f32 v17, v17, s64, -v22
v_fma_f32 v18, v18, s64, -v22
v_fma_f32 v19, v19, s64, -v22
v_exp_f32 v12, v12
v_exp_f32 v13, v13
v_exp_f32 v14, v14
v_exp_f32 v15, v15
v_exp_f32 v16, v16
v_exp_f32 v17, v17
v_exp_f32 v18, v18
v_exp_f32 v19, v19
v_cmp_eq_u32 vcc, s73, v0
v_cvt_pk_bf16_f32 v124, v12, v13
v_cvt_pk_bf16_f32 v125, v14, v15
v_cvt_pk_bf16_f32 v126, v16, v17
v_cvt_pk_bf16_f32 v127, v18, v19
v_cndmask_b32 v128, v128, v22, vcc
v_add_f32 v12, v12, v13
v_add_f32 v14, v14, v15
v_add_f32 v16, v16, v17
v_add_f32 v18, v18, v19
v_add_f32 v12, v12, v14
v_add_f32 v16, v16, v18
v_add_f32 v20, v12, v16
s_nop 1
v_add_f32_dpp v20, v20, v20 quad_perm:[1,0,3,2] row_mask:0xf bank_mask:0xf
s_nop 1
v_add_f32_dpp v20, v20, v20 quad_perm:[2,3,0,1] row_mask:0xf bank_mask:0xf
s_nop 1
v_add_f32_dpp v20, v20, v20 row_half_mirror row_mask:0xf bank_mask:0xf
s_nop 1
v_add_f32_dpp v20, v20, v20 row_mirror row_mask:0xf bank_mask:0xf
v_mov_b32 v21, v20
s_nop 1
v_permlane16_swap_b32 v21, v20
s_nop 1
v_add_f32 v20, v20, v21
v_mov_b32 v21, v20
s_nop 1
v_permlane32_swap_b32 v21, v20
s_nop 1
v_add_f32 v20, v20, v21
v_cndmask_b32 v129, v129, v20, vcc
s_cmp_eq_u32 s51, 0
s_cbranch_scc1 L_fin2
s_cmp_eq_u32 s54, 16
s_cbranch_scc0 L_fin1
v_mov_b32 v21, 0
s_mov_b32 s52, 1048576
L_sp7:
ds_read_b32 v20, v21 offset:588
s_sub_u32 s52, s52, 1
s_cbranch_scc1 L_sp7x
s_waitcnt lgkmcnt(0)
v_cmp_eq_u32 vcc, -1, v20
s_cbranch_vccnz L_sp7
L_sp7x:
s_waitcnt lgkmcnt(0)
v_readfirstlane_b32 s66, v20
s_and_b32 s66, s66, 1
s_xor_b32 s77, s55, s66
L_fin1:
s_cmp_eq_u32 s77, 0
s_cbranch_scc1 L_fin2
v_and_or_b32 v164, v124, s85, v160
v_and_or_b32 v165, v125, s85, v161
v_and_or_b32 v166, v126, s85, v162
v_and_or_b32 v167, v127, s85, v163
s_and_b32 s47, s73, 1
s_lshl_b32 s47, s47, 8
v_xor_b32 v20, s47, v168
buffer_store_dwordx4 v[164:167], v20, s[8:11], s88 offen sc1
s_cmp_eq_u32 s54, 4
s_cbranch_scc0 L_fin2
s_mov_b32 s52, 131072
L_sp8:
buffer_load_dwordx4 v[124:127], v168, s[8:11], s89 offen sc1
s_sub_u32 s52, s52, 1
s_cbranch_scc1 L_sp8x
s_waitcnt vmcnt(0)
v_xor_b32 v124, v124, v160
v_xor_b32 v125, v125, v161
v_xor_b32 v126, v126, v162
v_xor_b32 v127, v127, v163
v_or3_b32 v20, v124, v125, v126
v_bitop3_b32 v20, v20, v127, s85 bitop3:0x54
v_cmp_ne_u32 vcc, 0, v20
s_cbranch_vccnz L_sp8
L_sp8x:
s_waitcnt vmcnt(0)
L_fin2:
s_cmp_eq_u32 s54, 4
s_cbranch_scc0 L_fin3
ds_read_b128 v[8:11], v1 offset:0
v_mov_b32 v56, v126
v_mov_b32 v57, v127
s_mov_b32 s73, 0
s_sub_u32 s88, s88, 0x200000
s_sub_u32 s89, s89, 0x200000
s_waitcnt lgkmcnt(0)
s_branch L_h_done
L_pad2:
s_branch L_pad6
L_fin3:
s_mov_b32 s73, 1
s_cmp_eq_u32 s54, 24
s_cbranch_scc0 L_h_done
s_lshl_b32 s48, s42, 6
v_mov_b32 v130, s74
v_mov_b32 v131, s74
v_add_u32 v20, s48, v6
s_mov_b64 exec, 15
ds_write_b128 v20, v[128:131] offset:1024
s_mov_b64 exec, -1
s_branch L_h_done
L_pad3:
s_branch L_pad7
L_h7:
s_cmp_eq_u32 s51, 0
s_cbranch_scc1 L_h7b
v_mov_b32 v21, 0
s_mov_b32 s52, 1048576
L_sp9:
ds_read_b32 v20, v21 offset:584
s_sub_u32 s52, s52, 1
s_cbranch_scc1 L_sp9x
s_waitcnt lgkmcnt(0)
v_cmp_eq_u32 vcc, -1, v20
s_cbranch_vccnz L_sp9
L_sp9x:
s_waitcnt lgkmcnt(0)
v_readfirstlane_b32 s55, v20
s_and_b32 s55, s55, 1
L_h7b:
s_mov_b32 s4, s18
s_mov_b32 s5, s19
s_lshl_b32 s47, s55, 13
s_add_u32 s53, s72, s47
s_add_u32 s53, s53, 4294836224
s_branch L_h_done
L_pad4:
s_branch L_pad8
L_h8:
v_mov_b32_dpp v44, v44 row_ror:8 row_mask:0xf bank_mask:0xf
v_mov_b32_dpp v45, v45 row_ror:8 row_mask:0xf bank_mask:0xf
v_mov_b32_dpp v46, v46 row_ror:8 row_mask:0xf bank_mask:0xf
v_mov_b32_dpp v47, v47 row_ror:8 row_mask:0xf bank_mask:0xf
v_mov_b32 v52, v48
v_mov_b32 v53, v49
v_mov_b32 v54, v50
v_mov_b32 v55, v51
v_mov_b32 v48, 0
v_mov_b32 v49, 0
v_mov_b32 v50, 0
v_mov_b32 v51, 0
s_branch L_h_done
L_pad5:
s_branch L_pad9
L_h22:
s_cmp_eq_u32 s77, 0
s_cbranch_scc1 L_h_done
buffer_load_dwordx4 v[124:127], v168, s[8:11], s89 offen sc1
s_branch L_h_done
L_pad6:
s_branch L_pad10
L_h30:
s_cmp_eq_u32 s77, 0
s_cbranch_scc1 L_h_done
buffer_load_dwordx4 v[124:127], v169, s[8:11], s89 offen sc1
s_branch L_h_done
L_pad7:
s_branch L_pad11
L_h31:
s_cmp_eq_u32 s77, 0
s_cbranch_scc1 L_pc10
v_xor_b32 v124, v124, v160
v_xor_b32 v125, v125, v161
v_xor_b32 v126, v126, v162
v_xor_b32 v127, v127, v163
v_or3_b32 v20, v124, v125, v126
v_bitop3_b32 v20, v20, v127, s85 bitop3:0x54
v_cmp_ne_u32 vcc, 0, v20
s_cbranch_vccz L_pc10
s_mov_b32 s52, 131072
L_sp11:
buffer_load_dwordx4 v[124:127], v169, s[8:11], s89 offen sc1
s_sub_u32 s52, s52, 1
s_cbranch_scc1 L_sp11x
s_waitcnt vmcnt(0)
v_xor_b32 v124, v124, v160
v_xor_b32 v125, v125, v161
v_xor_b32 v126, v126, v162
v_xor_b32 v127, v127, v163
v_or3_b32 v20, v124, v125, v126
v_bitop3_b32 v20, v20, v127, s85 bitop3:0x54
v_cmp_ne_u32 vcc, 0, v20
s_cbranch_vccnz L_sp11
L_sp11x:
s_waitcnt vmcnt(0)
L_pc10:
s_branch L_h_done
L_pad8:
s_branch L_pad12
L_h23:
s_cmp_eq_u32 s77, 0
s_cbranch_scc1 L_pc12
v_xor_b32 v124, v124, v160
v_xor_b32 v125, v125, v161
v_xor_b32 v126, v126, v162
v_xor_b32 v127, v127, v163
v_or3_b32 v20, v124, v125, v126
v_bitop3_b32 v20, v20, v127, s85 bitop3:0x54
v_cmp_ne_u32 vcc, 0, v20
s_cbranch_vccz L_pc12
s_mov_b32 s52, 131072
L_sp13:
buffer_load_dwordx4 v[124:127], v168, s[8:11], s89 offen sc1
s_sub_u32 s52, s52, 1
s_cbranch_scc1 L_sp13x
s_waitcnt vmcnt(0)
v_xor_b32 v124, v124, v160
v_xor_b32 v125, v125, v161
v_xor_b32 v126, v126, v162
v_xor_b32 v127, v127, v163
v_or3_b32 v20, v124, v125, v126
v_bitop3_b32 v20, v20, v127, s85 bitop3:0x54
v_cmp_ne_u32 vcc, 0, v20
s_cbranch_vccnz L_sp13
L_sp13x:
s_waitcnt vmcnt(0)
L_pc12:
s_mov_b32 s4, s20
s_mov_b32 s5, s21
s_lshl_b32 s47, s66, 13
s_add_u32 s53, s72, s47
s_add_u32 s53, s53, 4294836224
s_branch L_h_done
L_pad9:
s_branch L_pad13
L_h32:
v_mov_b32_dpp v44, v44 row_ror:8 row_mask:0xf bank_mask:0xf
v_mov_b32_dpp v45, v45 row_ror:8 row_mask:0xf bank_mask:0xf
v_mov_b32_dpp v46, v46 row_ror:8 row_mask:0xf bank_mask:0xf
v_mov_b32_dpp v47, v47 row_ror:8 row_mask:0xf bank_mask:0xf
v_mov_b32 v56, v124
v_mov_b32 v57, v125
v_mov_b32 v58, v126
v_mov_b32 v59, v127
s_branch L_h_done
L_pad10:
s_branch L_pad14
L_h36:
s_xor_b32 s47, s46, s77
s_lshl_b32 s47, s47, 2
s_add_u32 s47, s47, s42
s_lshl_b32 s47, s47, 3
s_xor_b32 s48, s46, s67
s_lshl_b32 s48, s48, 2
s_add_u32 s48, s48, s42
s_lshl_b32 s48, s48, 3
v_lshrrev_b32 v24, 5, v0
v_lshl_add_u32 v20, v24, 6, s47
v_mov_b32 v21, s48
s_mov_b32 s52, 1048576
L_sp14:
ds_read_b64 v[132:133], v20 offset:1280
ds_read_b64 v[22:23], v21 offset:1408
s_sub_u32 s52, s52, 1
s_cbranch_scc1 L_sp14x
s_waitcnt lgkmcnt(0)
v_cmp_ne_u32 vcc, s74, v133
v_cmp_ne_u32 s[48:49], s74, v23
s_or_b64 vcc, vcc, s[48:49]
s_cbranch_scc1 L_sp14
L_sp14x:
s_waitcnt lgkmcnt(0)
v_mul_f32 v52, v22, v52
v_mul_f32 v53, v22, v53
v_mul_f32 v54, v22, v54
v_mul_f32 v55, v22, v55
v_lshlrev_b32 v1, 1, v1
v_lshl_add_u32 v1, v24, 9, v1
v_and_b32 v20, 16, v0
s_lshl_b32 s47, s42, 10
v_add3_u32 v1, v1, v20, s47
s_branch L_h_done
L_pad11:
s_branch L_pad15
L_h39:
s_mov_b32 s6, 0
L_h_done:
s_add_u32 s53, s53, 0x20000
s_add_u32 s54, s54, 1
s_bitcmp1_b64 s[78:79], s54
s_cbranch_scc1 L_vbody
s_branch L_kbody
L_pad12:
s_branch L_padret
L_sfin:
s_nop 1
v_mul_f32 v48, v132, v48
v_mul_f32 v49, v132, v49
v_mul_f32 v50, v132, v50
v_mul_f32 v51, v132, v51
v_permlane32_swap_b32 v48, v52
v_permlane32_swap_b32 v49, v53
v_permlane32_swap_b32 v50, v54
v_permlane32_swap_b32 v51, v55
v_add_f32 v48, v48, v52
v_add_f32 v49, v49, v53
v_add_f32 v50, v50, v54
v_add_f32 v51, v51, v55
ds_write_b128 v1, v[48:51] offset:10240
buffer_load_dwordx4 v136, s[12:15], s92 offen offset:0 nt lds
buffer_load_dwordx4 v137, s[12:15], s92 offen offset:1024 nt lds
s_waitcnt lgkmcnt(0)
s_barrier
v_lshrrev_b32 v20, 4, v0
v_and_b32 v24, 15, v0
s_barrier
buffer_load_dwordx4 v138, s[12:15], s92 offen offset:2048 nt lds
buffer_load_dwordx4 v139, s[12:15], s92 offen offset:3072 nt lds
s_add_u32 m0, m0, 4096
s_nop 0
buffer_load_dwordx4 v136, s[12:15], s93 offen offset:0 nt lds
buffer_load_dwordx4 v137, s[12:15], s93 offen offset:1024 nt lds
buffer_load_dwordx4 v138, s[12:15], s93 offen offset:2048 nt lds
buffer_load_dwordx4 v139, s[12:15], s93 offen offset:3072 nt lds
v_bfe_u32 v22, v0, 2, 3
s_lshl_b32 s49, s42, 1
v_xor_b32 v22, s49, v22
v_lshlrev_b32 v173, 5, v22
v_lshl_add_u32 v173, v20, 8, v173
v_bfe_u32 v22, v0, 2, 2
v_lshl_add_u32 v173, v22, 10, v173
v_and_b32 v22, 3, v0
v_lshl_add_u32 v173, v22, 3, v173
v_xor_b32 v174, 32, v173
v_lshlrev_b32 v244, 6, v24
v_lshl_add_u32 v244, v20, 4, v244
s_and_b32 s49, s42, 1
s_lshl_b32 s49, s49, 1
v_lshrrev_b32 v20, 5, v0
v_or_b32 v20, s49, v20
s_lshl_b32 s49, s2, 1
s_and_b32 s49, s49, 127
s_lshr_b32 s75, s42, 1
s_or_b32 s49, s49, s75
v_xor_b32 v21, s49, v20
v_lshlrev_b32 v171, 8, v21
v_lshl_add_u32 v171, v20, 15, v171
v_and_b32 v20, 31, v0
v_lshl_add_u32 v171, v20, 3, v171
s_lshr_b32 s75, s2, 6
s_lshl_b32 s75, s75, 17
s_add_u32 s75, s75, 524288
s_lshl_b32 s49, s42, 9
v_lshl_add_u32 v170, v0, 3, s49
s_add_u32 s74, s74, 1
s_and_b32 s49, s74, 0xff
v_mov_b32 v248, s49
s_lshr_b32 s49, s74, 8
s_xor_b32 s49, s49, s74
s_and_b32 s49, s49, 0xff
v_mov_b32 v249, s49
s_lshr_b32 s49, s74, 16
s_xor_b32 s49, s49, s74
s_and_b32 s49, s49, 0xff
v_mov_b32 v250, s49
s_lshr_b32 s49, s74, 24
s_xor_b32 s49, s49, s74
s_and_b32 s49, s49, 0xff
v_mov_b32 v251, s49
s_getreg_b32 s49, hwreg(HW_REG_XCC_ID, 0, 4)
v_xor_b32 v251, s49, v251
v_cndmask_b32 v248, v248, v250, s[62:63]
v_cndmask_b32 v249, v249, v251, s[62:63]
s_waitcnt vmcnt(0)
s_barrier
ds_read_b128 v[208:211], v244 offset:2048
ds_read_b64_tr_b16 v[176:177], v173 offset:16384
ds_read_b64_tr_b16 v[178:179], v173 offset:20480
ds_read_b64_tr_b16 v[180:181], v174 offset:16384
ds_read_b64_tr_b16 v[182:183], v174 offset:20480
ds_read_b64_tr_b16 v[184:185], v173 offset:24576
ds_read_b64_tr_b16 v[186:187], v173 offset:28672
ds_read_b64_tr_b16 v[188:189], v174 offset:24576
ds_read_b64_tr_b16 v[190:191], v174 offset:28672
ds_read_b64_tr_b16 v[192:193], v173 offset:32768
ds_read_b64_tr_b16 v[194:195], v173 offset:36864
ds_read_b64_tr_b16 v[196:197], v174 offset:32768
ds_read_b64_tr_b16 v[198:199], v174 offset:36864
ds_read_b64_tr_b16 v[200:201], v173 offset:40960
ds_read_b64_tr_b16 v[202:203], v173 offset:45056
s_waitcnt lgkmcnt(12)
ds_read_b64_tr_b16 v[204:205], v174 offset:40960
ds_read_b64_tr_b16 v[206:207], v174 offset:45056
v_mfma_f32_16x16x32_bf16 v[212:215], v[208:211], v[176:179], 0
s_waitcnt lgkmcnt(12)
v_mfma_f32_16x16x32_bf16 v[216:219], v[208:211], v[180:183], 0
s_waitcnt lgkmcnt(10)
v_mfma_f32_16x16x32_bf16 v[220:223], v[208:211], v[184:187], 0
s_waitcnt lgkmcnt(8)
v_mfma_f32_16x16x32_bf16 v[224:227], v[208:211], v[188:191], 0
s_waitcnt lgkmcnt(6)
v_mfma_f32_16x16x32_bf16 v[228:231], v[208:211], v[192:195], 0
s_waitcnt lgkmcnt(4)
v_mfma_f32_16x16x32_bf16 v[232:235], v[208:211], v[196:199], 0
s_waitcnt lgkmcnt(2)
v_mfma_f32_16x16x32_bf16 v[236:239], v[208:211], v[200:203], 0
s_waitcnt lgkmcnt(0)
v_mfma_f32_16x16x32_bf16 v[240:243], v[208:211], v[204:207], 0
v_add_f32 v48, v212, v221
v_add_f32 v49, v216, v225
s_nop 0
v_add_f32 v48, v48, v230
v_add_f32 v49, v49, v234
s_nop 1
v_add_f32 v48, v48, v239
v_add_f32 v49, v49, v243
v_and_or_b32 v48, v48, s76, v248
v_and_or_b32 v49, v49, s76, v249
buffer_store_dwordx2 v[48:49], v171, s[8:11], s75 offen
ds_write_b64 v170, v[48:49] offset:14336
s_waitcnt lgkmcnt(0)
s_barrier
s_endpgm
L_late2o:
s_lshl_b32 s47, s45, 5
s_add_u32 s47, s47, s43
s_lshl_b32 s94, s47, 21
s_lshl_b32 s47, s46, 18
s_add_u32 s94, s94, s47
s_sub_u32 s47, s42, 0
s_mul_i32 s47, s47, 0x82000
s_and_b32 s47, s47, 0x182000
s_add_u32 s94, s94, s47
s_memtime s[96:97]
s_waitcnt lgkmcnt(0)
s_mul_i32 s69, s96, 0x9e3779b1
s_lshr_b32 s69, s69, 9
s_mov_b32 s92, 0x10000
s_mov_b32 s93, 0x10000
s_mov_b32 s100, 0
s_mov_b32 s95, 2
L_pr1:
s_memtime s[96:97]
s_and_b32 s49, s69, 0x3df80
s_xor_b32 s49, s49, s94
s_waitcnt lgkmcnt(0)
s_buffer_load_dword s101, s[4:7], s49
s_waitcnt lgkmcnt(0)
s_memtime s[98:99]
s_waitcnt lgkmcnt(0)
s_sub_u32 s47, s98, s96
s_cmp_lt_u32 s47, 400
s_cselect_b32 s47, 0x10000, s47
s_bitcmp1_b32 s94, 13
s_cselect_b32 s48, 0x10000, s47
s_cselect_b32 s47, s47, 0x10000
s_min_u32 s92, s92, s48
s_min_u32 s93, s93, s47
s_xor_b32 s94, s94, 0x2000
s_add_u32 s69, s69, s98
s_mul_i32 s69, s69, 0x9e3779b1
s_lshr_b32 s47, s69, 14
s_xor_b32 s69, s69, s47
s_sub_u32 s95, s95, 1
s_cmp_lg_u32 s95, 0
s_cbranch_scc1 L_pr1
s_branch L_late2
L_pad13:
s_branch L_padret
L_late1o:
s_add_u32 s101, s74, 1
s_sub_i32 s92, s92, s93
s_min_i32 s92, s92, 1500
s_max_i32 s92, s92, -1500
s_lshl_b32 s47, s100, 2
s_mov_b64 exec, 1
v_mov_b32 v24, s47
v_mov_b32 v25, s92
v_mov_b32 v26, 1
ds_add_u32 v24, v25 offset:544
ds_add_u32 v24, v26 offset:528
s_cmp_lg_u32 s42, 0
s_cbranch_scc1 L_sp0
s_mov_b32 s52, 1048576
L_sp2:
ds_read_b32 v26, v24 offset:528
s_sub_u32 s52, s52, 1
s_cbranch_scc1 L_sp2x
s_waitcnt lgkmcnt(0)
v_cmp_ne_u32 vcc, 4, v26
s_cbranch_vccnz L_sp2
L_sp2x:
s_waitcnt lgkmcnt(0)
ds_read_b32 v28, v24 offset:544
v_mov_b32 v29, s101
v_mov_b32 v30, s101
v_mov_b32 v31, s101
s_lshl_b32 s47, s2, 8
s_lshl_b32 s48, s100, 6
s_add_u32 s47, s47, s48
s_add_u32 s47, s47, 1572864
s_xor_b32 s48, s47, 0x400
s_waitcnt lgkmcnt(0)
buffer_store_dwordx4 v[28:31], off, s[8:11], s47 sc1
s_mov_b32 s52, 131072
L_sp3:
buffer_load_dwordx4 v[32:35], off, s[8:11], s48 sc1
s_sub_u32 s52, s52, 1
s_cbranch_scc1 L_sp3x
s_waitcnt vmcnt(0)
v_xor_b32 v33, s101, v33
v_xor_b32 v34, s101, v34
v_or_b32 v33, v33, v34
v_cmp_ne_u32 vcc, 0, v33
s_cbranch_vccnz L_sp3
L_sp3x:
s_waitcnt vmcnt(0)
v_sub_u32 v26, v28, v32
v_sub_u32 v27, v32, v28
s_cmp_eq_u32 s46, 0
s_cselect_b64 vcc, -1, 0
v_cndmask_b32 v26, v27, v26, vcc
v_cmp_lt_i32 vcc, 0, v26
s_nop 1
v_cndmask_b32 v26, 0, 1, vcc
v_xor_b32 v26, s46, v26
ds_write_b32 v24, v26 offset:576
L_sp0:
s_mov_b64 exec, -1
v_mov_b32 v21, 0
s_mov_b32 s52, 1048576
L_sp4:
ds_read_b32 v20, v21 offset:576
s_sub_u32 s52, s52, 1
s_cbranch_scc1 L_sp4x
s_waitcnt lgkmcnt(0)
v_cmp_eq_u32 vcc, -1, v20
s_cbranch_vccnz L_sp4
L_sp4x:
s_waitcnt lgkmcnt(0)
v_readfirstlane_b32 s55, v20
s_and_b32 s55, s55, 1
v_and_b32 v2, 0xffffdfff, v2
v_and_b32 v3, 0xffffdfff, v3
v_and_b32 v4, 0xffffdfff, v4
v_and_b32 v5, 0xffffdfff, v5
s_lshl_b32 s47, s55, 13
s_add_u32 s53, s53, s47
s_mov_b32 s50, 1
buffer_load_dwordx4 v[124:127], v2, s[4:7], s53 offen offset:0 nt
buffer_load_dwordx4 v[128:131], v2, s[4:7], s53 offen offset:1024 nt
buffer_load_dwordx4 v[132:135], v2, s[4:7], s53 offen offset:2048 nt
buffer_load_dwordx4 v[136:139], v2, s[4:7], s53 offen offset:3072 nt
buffer_load_dwordx4 v[140:143], v3, s[4:7], s53 offen offset:0 nt
buffer_load_dwordx4 v[144:147], v3, s[4:7], s53 offen offset:1024 nt
s_branch L_late1
L_pad14:
s_branch L_padret
L_nc3o:
v_and_b32 v20, 3, v0
v_lshlrev_b32 v20, 3, v20
s_and_b32 s47, s74, 0xffffff00
v_lshrrev_b32 v20, v20, s47
v_mul_u32_u24 v21, 37, v0
v_xor_b32 v20, s74, v20
v_xor_b32 v20, v21, v20
v_bfe_u32 v21, v20, 0, 1
v_bfe_u32 v22, v20, 1, 1
v_lshlrev_b32 v21, 15, v21
v_lshl_or_b32 v160, v22, 31, v21
v_bfe_u32 v21, v20, 2, 1
v_bfe_u32 v22, v20, 3, 1
v_lshlrev_b32 v21, 15, v21
v_lshl_or_b32 v161, v22, 31, v21
v_bfe_u32 v21, v20, 4, 1
v_bfe_u32 v22, v20, 5, 1
v_lshlrev_b32 v21, 15, v21
v_lshl_or_b32 v162, v22, 31, v21
v_bfe_u32 v21, v20, 6, 1
v_bfe_u32 v22, v20, 7, 1
v_lshlrev_b32 v21, 15, v21
v_lshl_or_b32 v163, v22, 31, v21
s_mov_b32 s85, 0x7fff7fff
v_lshrrev_b32 v20, 4, v0
v_lshl_add_u32 v168, v20, 15, v6
s_and_b32 s47, s42, 1
s_lshl_b32 s47, s47, 9
v_xor_b32 v168, s47, v168
v_xor_b32 v169, 0x100, v168
s_lshr_b32 s47, s42, 1
s_lshl_b32 s47, s47, 10
s_and_b32 s48, s2, 15
s_lshl_b32 s48, s48, 11
s_add_u32 s47, s47, s48
s_lshr_b32 s48, s2, 4
s_lshl_b32 s48, s48, 17
s_add_u32 s47, s47, s48
s_add_u32 s88, s47, 4194304
s_xor_b32 s89, s88, 0x2000
s_or_b32 s70, s70, 0xc0400000
s_mov_b32 s68, 516
v_mov_b32 v21, 0
s_mov_b32 s52, 1048576
L_sp6:
ds_read_b32 v20, v21 offset:580
s_sub_u32 s52, s52, 1
s_cbranch_scc1 L_sp6x
s_waitcnt lgkmcnt(0)
v_cmp_eq_u32 vcc, -1, v20
s_cbranch_vccnz L_sp6
L_sp6x:
s_waitcnt lgkmcnt(0)
v_readfirstlane_b32 s66, v20
s_and_b32 s66, s66, 1
s_xor_b32 s67, s55, s66
s_mov_b32 s77, s67
s_branch L_nc3
L_pad15:
s_branch L_padret
L_service2:
v_mov_b32 v7, 0
v_lshlrev_b32 v72, 2, v0
v_cmp_lt_u32 vcc, 15, v0
s_cmp_eq_u32 s51, 1
s_cselect_b32 s47, 1, 0
v_cndmask_b32 v73, 0, -1, vcc
v_writelane_b32 v73, s47, 1
ds_write_b32 v72, v73 offset:512
s_waitcnt lgkmcnt(0)
s_mov_b32 s74, 1376256
s_load_dword s74, s[40:41], s74
s_barrier
s_mov_b32 s8, s40
s_mov_b32 s9, s41
v_lshlrev_b32 v6, 4, v0
s_lshl_b32 s47, s42, 3
s_add_u32 s47, s47, s44
s_cmp_ge_u32 s47, 10
s_cbranch_scc1 L_norc
s_lshl_b32 s47, s47, 5
s_add_u32 s47, s47, s43
s_lshl_b32 s47, s47, 8
s_add_u32 s47, s47, 1441792
s_mov_b64 exec, 0xffff
buffer_store_dword v7, v72, s[8:11], s47 offen sc1
s_mov_b64 exec, -1
L_norc:
v_and_b32 v72, 7, v0
v_and_b32 v73, 1, v0
v_lshlrev_b32 v73, 4, v73
v_mov_b32 v74, 0xffff
v_lshlrev_b32 v74, v73, v74
v_lshrrev_b32 v72, 1, v72
v_mov_b32 v76, 0x0c0c0c0c
s_mov_b32 s47, 0x01000100
s_mov_b32 s48, 0x03020302
v_cmp_eq_u32 vcc, 0, v72
s_nop 1
v_cndmask_b32 v75, 0, v74, vcc
v_bfi_b32 v48, v75, s47, v76
v_bfi_b32 v52, v75, s48, v76
v_cmp_eq_u32 vcc, 1, v72
s_nop 1
v_cndmask_b32 v75, 0, v74, vcc
v_bfi_b32 v49, v75, s47, v76
v_bfi_b32 v53, v75, s48, v76
v_cmp_eq_u32 vcc, 2, v72
s_nop 1
v_cndmask_b32 v75, 0, v74, vcc
v_bfi_b32 v50, v75, s47, v76
v_bfi_b32 v54, v75, s48, v76
v_cmp_eq_u32 vcc, 3, v72
s_nop 1
v_cndmask_b32 v75, 0, v74, vcc
v_bfi_b32 v51, v75, s47, v76
v_bfi_b32 v55, v75, s48, v76
v_lshrrev_b32 v72, 5, v0
v_lshlrev_b32 v4, 9, v72
v_lshl_add_u32 v4, v3, 5, v4
v_and_b32 v72, 16, v0
s_lshl_b32 s47, s42, 11
v_add3_u32 v4, v4, v72, s47
v_lshl_add_u32 v5, v2, 15, v6
s_lshl_b32 s47, s2, 1
s_and_b32 s47, s47, 127
s_lshl_b32 s47, s47, 8
v_xor_b32 v5, s47, v5
v_xor_b32 v104, 0x100, v5
s_lshr_b32 s54, s2, 6
s_lshl_b32 s54, s54, 17
s_waitcnt lgkmcnt(0)
s_add_u32 s74, s74, 1
s_and_b32 s47, s74, 0xff
v_mov_b32 v112, s47
s_lshr_b32 s47, s74, 8
s_xor_b32 s47, s47, s74
s_and_b32 s47, s47, 0xff
v_mov_b32 v113, s47
s_lshr_b32 s47, s74, 16
s_xor_b32 s47, s47, s74
s_and_b32 s47, s47, 0xff
v_mov_b32 v114, s47
s_lshr_b32 s47, s74, 24
s_xor_b32 s47, s47, s74
s_and_b32 s47, s47, 0xff
v_mov_b32 v115, s47
s_cmp_eq_u32 s42, 0
s_cselect_b32 s51, 0, s51
s_mov_b32 s100, 1
s_mov_b64 s[12:13], s[28:29]
s_cmp_eq_u32 s100, 1
s_cselect_b64 s[12:13], s[30:31], s[12:13]
s_cmp_eq_u32 s100, 2
s_cselect_b64 s[12:13], s[18:19], s[12:13]
s_cmp_eq_u32 s100, 3
s_cselect_b64 s[12:13], s[20:21], s[12:13]
s_mov_b32 s14, 0x10000000
s_mov_b32 s92, 0x10000
s_mov_b32 s93, 0x10000
s_cmp_eq_u32 s51, 0
s_cbranch_scc1 L_nop0
s_lshl_b32 s47, s45, 5
s_add_u32 s47, s47, s43
s_lshl_b32 s94, s47, 21
s_lshl_b32 s47, s46, 18
s_add_u32 s94, s94, s47
s_sub_u32 s47, s42, 1
s_mul_i32 s47, s47, 0x82000
s_and_b32 s47, s47, 0x182000
s_add_u32 s94, s94, s47
s_memtime s[96:97]
s_waitcnt lgkmcnt(0)
s_mul_i32 s69, s96, 0x9e3779b1
s_lshr_b32 s69, s69, 9
L_nop0:
s_cmp_eq_u32 s42, 0
s_cbranch_scc1 L_pad0
s_cmp_eq_u32 s42, 1
s_cbranch_scc1 L_pad1
s_cmp_eq_u32 s42, 2
s_cbranch_scc1 L_pad2
s_branch L_pad3
L_padret:
s_waitcnt vmcnt(0)
v_perm_b32 v56, v8, v8, v48
v_perm_b32 v57, v8, v8, v49
v_perm_b32 v58, v8, v8, v50
v_perm_b32 v59, v8, v8, v51
v_perm_b32 v60, v12, v12, v48
v_perm_b32 v61, v12, v12, v49
v_perm_b32 v62, v12, v12, v50
v_perm_b32 v63, v12, v12, v51
v_mfma_f32_16x16x32_bf16 v[64:67], v[56:59], v[16:19], 0
v_perm_b32 v56, v8, v8, v52
v_perm_b32 v57, v8, v8, v53
v_perm_b32 v58, v8, v8, v54
v_perm_b32 v59, v8, v8, v55
v_mfma_f32_16x16x32_bf16 v[68:71], v[60:63], v[16:19], 0
v_perm_b32 v60, v12, v12, v52
v_perm_b32 v61, v12, v12, v53
v_perm_b32 v62, v12, v12, v54
v_perm_b32 v63, v12, v12, v55
v_mfma_f32_16x16x32_bf16 v[64:67], v[56:59], v[20:23], v[64:67]
v_perm_b32 v56, v9, v9, v48
v_perm_b32 v57, v9, v9, v49
v_perm_b32 v58, v9, v9, v50
v_perm_b32 v59, v9, v9, v51
v_mfma_f32_16x16x32_bf16 v[68:71], v[60:63], v[20:23], v[68:71]
v_perm_b32 v60, v13, v13, v48
v_perm_b32 v61, v13, v13, v49
v_perm_b32 v62, v13, v13, v50
v_perm_b32 v63, v13, v13, v51
v_mfma_f32_16x16x32_bf16 v[64:67], v[56:59], v[24:27], v[64:67]
v_perm_b32 v56, v9, v9, v52
v_perm_b32 v57, v9, v9, v53
v_perm_b32 v58, v9, v9, v54
v_perm_b32 v59, v9, v9, v55
v_mfma_f32_16x16x32_bf16 v[68:71], v[60:63], v[24:27], v[68:71]
v_perm_b32 v60, v13, v13, v52
v_perm_b32 v61, v13, v13, v53
v_perm_b32 v62, v13, v13, v54
v_perm_b32 v63, v13, v13, v55
v_mfma_f32_16x16x32_bf16 v[64:67], v[56:59], v[28:31], v[64:67]
v_perm_b32 v56, v10, v10, v48
v_perm_b32 v57, v10, v10, v49
v_perm_b32 v58, v10, v10, v50
v_perm_b32 v59, v10, v10, v51
v_mfma_f32_16x16x32_bf16 v[68:71], v[60:63], v[28:31], v[68:71]
v_perm_b32 v60, v14, v14, v48
v_perm_b32 v61, v14, v14, v49
v_perm_b32 v62, v14, v14, v50
v_perm_b32 v63, v14, v14, v51
v_mfma_f32_16x16x32_bf16 v[64:67], v[56:59], v[32:35], v[64:67]
v_perm_b32 v56, v10, v10, v52
v_perm_b32 v57, v10, v10, v53
v_perm_b32 v58, v10, v10, v54
v_perm_b32 v59, v10, v10, v55
v_mfma_f32_16x16x32_bf16 v[68:71], v[60:63], v[32:35], v[68:71]
v_perm_b32 v60, v14, v14, v52
v_perm_b32 v61, v14, v14, v53
v_perm_b32 v62, v14, v14, v54
v_perm_b32 v63, v14, v14, v55
v_mfma_f32_16x16x32_bf16 v[64:67], v[56:59], v[36:39], v[64:67]
v_perm_b32 v56, v11, v11, v48
v_perm_b32 v57, v11, v11, v49
v_perm_b32 v58, v11, v11, v50
v_perm_b32 v59, v11, v11, v51
v_mfma_f32_16x16x32_bf16 v[68:71], v[60:63], v[36:39], v[68:71]
v_perm_b32 v60, v15, v15, v48
v_perm_b32 v61, v15, v15, v49
v_perm_b32 v62, v15, v15, v50
v_perm_b32 v63, v15, v15, v51
v_mfma_f32_16x16x32_bf16 v[64:67], v[56:59], v[40:43], v[64:67]
v_perm_b32 v56, v11, v11, v52
v_perm_b32 v57, v11, v11, v53
v_perm_b32 v58, v11, v11, v54
v_perm_b32 v59, v11, v11, v55
v_mfma_f32_16x16x32_bf16 v[68:71], v[60:63], v[40:43], v[68:71]
v_perm_b32 v60, v15, v15, v52
v_perm_b32 v61, v15, v15, v53
v_perm_b32 v62, v15, v15, v54
v_perm_b32 v63, v15, v15, v55
v_mfma_f32_16x16x32_bf16 v[64:67], v[56:59], v[44:47], v[64:67]
s_nop 0
v_mfma_f32_16x16x32_bf16 v[68:71], v[60:63], v[44:47], v[68:71]
v_mov_b32 v72, 1
s_nop 5
ds_write_b128 v4, v[64:67] offset:2048
ds_write_b128 v4, v[68:71] offset:3072
s_mov_b64 exec, 1
ds_add_u32 v7, v72 offset:512
s_mov_b64 exec, -1
s_cmp_lg_u32 s42, 0
s_cbranch_scc1 L_notleader
s_mov_b32 s52, 1048576
L_sp15:
ds_read_b32 v72, v7 offset:512
s_sub_u32 s52, s52, 1
s_cbranch_scc1 L_sp15x
s_waitcnt lgkmcnt(0)
v_cmp_ne_u32 vcc, 4, v72
s_cbranch_vccnz L_sp15
L_sp15x:
s_waitcnt lgkmcnt(0)
ds_read_b128 v[64:67], v6 offset:2048
ds_read_b128 v[68:71], v6 offset:3072
ds_read_b128 v[72:75], v6 offset:4096
ds_read_b128 v[76:79], v6 offset:5120
ds_read_b128 v[80:83], v6 offset:6144
ds_read_b128 v[84:87], v6 offset:7168
ds_read_b128 v[88:91], v6 offset:8192
ds_read_b128 v[92:95], v6 offset:9216
s_waitcnt lgkmcnt(4)
v_add_f32 v64, v64, v72
v_add_f32 v65, v65, v73
v_add_f32 v66, v66, v74
v_add_f32 v67, v67, v75
v_add_f32 v68, v68, v76
v_add_f32 v69, v69, v77
v_add_f32 v70, v70, v78
v_add_f32 v71, v71, v79
s_waitcnt lgkmcnt(0)
v_add_f32 v80, v80, v88
v_add_f32 v81, v81, v89
v_add_f32 v82, v82, v90
v_add_f32 v83, v83, v91
v_add_f32 v84, v84, v92
v_add_f32 v85, v85, v93
v_add_f32 v86, v86, v94
v_add_f32 v87, v87, v95
v_add_f32 v64, v64, v80
v_add_f32 v65, v65, v81
v_add_f32 v66, v66, v82
v_add_f32 v67, v67, v83
v_add_f32 v68, v68, v84
v_add_f32 v69, v69, v85
v_add_f32 v70, v70, v86
v_add_f32 v71, v71, v87
v_and_or_b32 v64, v64, s76, v112
v_and_or_b32 v65, v65, s76, v113
v_and_or_b32 v66, v66, s76, v114
v_and_or_b32 v67, v67, s76, v115
v_and_or_b32 v68, v68, s76, v112
v_and_or_b32 v69, v69, s76, v113
v_and_or_b32 v70, v70, s76, v114
v_and_or_b32 v71, v71, s76, v115
buffer_store_dwordx4 v[64:67], v5, s[8:11], s54 offen sc1
buffer_store_dwordx4 v[68:71], v104, s[8:11], s54 offen sc1
v_bfe_u32 v72, v0, 4, 1
s_and_b32 s47, s45, 1
s_lshl_b32 s47, s47, 1
v_or_b32 v72, s47, v72
v_lshrrev_b32 v73, 5, v0
v_lshlrev_b32 v73, 3, v73
s_and_b32 s47, s43, 7
s_lshl_b32 s47, s47, 4
s_lshr_b32 s48, s45, 1
s_or_b32 s47, s47, s48
v_or_b32 v73, s47, v73
v_xor_b32 v73, v73, v72
v_lshlrev_b32 v73, 8, v73
v_lshl_add_u32 v73, v72, 15, v73
v_lshl_add_u32 v72, v3, 4, v73
v_xor_b32 v73, 0x200, v72
s_xor_b32 s47, s74, 1
v_mov_b32 v92, s47
v_mov_b32 v93, s47
v_lshlrev_b32 v94, 3, v0
ds_write_b64 v94, v[92:93] offset:1024
s_mov_b32 s52, 131072
L_sp16:
buffer_load_dwordx4 v[76:79], v72, s[8:11], s54 offen offset:0 sc1
buffer_load_dwordx4 v[80:83], v73, s[8:11], s54 offen offset:0 sc1
buffer_load_dwordx4 v[84:87], v72, s[8:11], s54 offen offset:1024 sc1
buffer_load_dwordx4 v[88:91], v73, s[8:11], s54 offen offset:1024 sc1
s_sub_u32 s52, s52, 1
s_cbranch_scc1 L_sp16x
s_waitcnt vmcnt(0)
v_xor_b32 v76, v76, v112
v_xor_b32 v77, v77, v113
v_xor_b32 v78, v78, v114
v_xor_b32 v79, v79, v115
v_xor_b32 v80, v80, v112
v_xor_b32 v81, v81, v113
v_xor_b32 v82, v82, v114
v_xor_b32 v83, v83, v115
v_xor_b32 v84, v84, v112
v_xor_b32 v85, v85, v113
v_xor_b32 v86, v86, v114
v_xor_b32 v87, v87, v115
v_xor_b32 v88, v88, v112
v_xor_b32 v89, v89, v113
v_xor_b32 v90, v90, v114
v_xor_b32 v91, v91, v115
v_or3_b32 v74, v76, v77, v78
v_or3_b32 v74, v74, v79, v80
v_or3_b32 v74, v74, v81, v82
v_or3_b32 v74, v74, v83, v84
v_or3_b32 v74, v74, v85, v86
v_or3_b32 v74, v74, v87, v88
v_or3_b32 v74, v74, v89, v90
v_bitop3_b32 v74, v74, v91, s76 bitop3:0x54
v_cmp_ne_u32 vcc, 0, v74
s_cbranch_vccnz L_sp16
L_sp16x:
s_waitcnt vmcnt(0)
v_add_f32 v76, v76, v80
v_add_f32 v84, v84, v88
v_add_f32 v77, v77, v81
v_add_f32 v85, v85, v89
v_add_f32 v78, v78, v82
v_add_f32 v86, v86, v90
v_add_f32 v79, v79, v83
v_add_f32 v87, v87, v91
v_add_f32 v76, v76, v84
v_add_f32 v77, v77, v85
v_add_f32 v78, v78, v86
v_add_f32 v79, v79, v87
v_cvt_pk_bf16_f32 v76, v76, v77
v_cvt_pk_bf16_f32 v77, v78, v79
ds_write_b64 v94, v[76:77] offset:0
ds_write_b32 v7, v7 offset:592
s_waitcnt lgkmcnt(0)
s_mov_b64 exec, 0xffff
s_mov_b32 s52, 1048576
L_sp17:
ds_read_b128 v[64:67], v6 offset:1024
s_sub_u32 s52, s52, 1
s_cbranch_scc1 L_sp17x
s_waitcnt lgkmcnt(0)
v_cmp_ne_u32 vcc, s74, v66
s_cbranch_vccnz L_sp17
L_sp17x:
s_waitcnt lgkmcnt(0)
s_lshl_b32 s47, s2, 8
s_add_u32 s47, s47, 1310720
buffer_store_dwordx4 v[64:67], v6, s[8:11], s47 offen sc1
s_mov_b64 exec, -1
v_and_b32 v72, 3, v0
v_lshlrev_b32 v4, 6, v72
v_bfe_u32 v72, v0, 2, 1
v_lshl_add_u32 v4, v72, 10, v4
v_lshrrev_b32 v72, 3, v0
v_min_u32 v72, 2, v72
v_lshl_add_u32 v4, v72, 4, v4
s_andn2_b32 s47, s47, 0x400
s_mov_b32 s52, 131072
L_sp18:
buffer_load_dwordx4 v[76:79], v4, s[8:11], s47 offen sc1
s_sub_u32 s52, s52, 1
s_cbranch_scc1 L_sp18x
s_waitcnt vmcnt(0)
v_cmp_ne_u32 vcc, s74, v78
s_cbranch_vccnz L_sp18
L_sp18x:
s_waitcnt vmcnt(0)
v_mov_b32 v72, v76
s_nop 1
v_max_f32_dpp v72, v72, v72 quad_perm:[1,0,3,2] row_mask:0xf bank_mask:0xf
s_nop 1
v_max_f32_dpp v72, v72, v72 quad_perm:[2,3,0,1] row_mask:0xf bank_mask:0xf
s_nop 1
v_max_f32_dpp v72, v72, v72 row_half_mirror row_mask:0xf bank_mask:0xf
s_nop 1
v_max_f32_dpp v72, v72, v72 row_mirror row_mask:0xf bank_mask:0xf
v_sub_f32 v72, v76, v72
v_exp_f32 v72, v72
v_cmp_lt_u32 vcc, 15, v0
v_mul_f32 v73, v72, v77
s_nop 1
v_add_f32_dpp v73, v73, v73 quad_perm:[1,0,3,2] row_mask:0xf bank_mask:0xf
s_nop 1
v_add_f32_dpp v73, v73, v73 quad_perm:[2,3,0,1] row_mask:0xf bank_mask:0xf
s_nop 1
v_add_f32_dpp v73, v73, v73 row_half_mirror row_mask:0xf bank_mask:0xf
s_nop 1
v_add_f32_dpp v73, v73, v73 row_mirror row_mask:0xf bank_mask:0xf
v_rcp_f32 v73, v73
v_cndmask_b32 v74, 1.0, 2.0, vcc
v_mul_f32 v72, v72, v73
v_mul_f32 v72, v72, v74
v_mov_b32 v73, s74
s_mov_b32 exec_hi, 0
ds_write_b64 v94, v[72:73] offset:1280
s_mov_b64 exec, -1
v_bfe_u32 v72, v0, 2, 3
v_lshlrev_b32 v109, 12, v72
v_lshrrev_b32 v72, 5, v0
v_lshl_add_u32 v109, v72, 17, v109
v_and_b32 v72, 3, v0
v_lshl_add_u32 v109, v72, 4, v109
v_lshlrev_b32 v110, 2, v72
v_bfe_u32 v72, v0, 2, 1
v_lshl_add_u32 v110, v72, 5, v110
v_bfe_u32 v72, v0, 3, 1
v_lshl_add_u32 v110, v72, 1, v110
s_bfe_u32 s47, s43, 0x20001
s_lshl_b32 s59, s47, 11
s_lshr_b32 s47, s43, 3
s_lshl_b32 s47, s47, 6
s_add_u32 s59, s59, s47
s_and_b32 s47, s43, 1
s_lshl_b32 s47, s47, 4
s_add_u32 s59, s59, s47
s_bfe_u32 s47, s43, 0x20002
s_lshr_b32 s49, s43, 4
s_lshl_b32 s48, s44, 1
s_or_b32 s48, s48, s49
s_xor_b32 s48, s48, s47
s_lshl_b32 s48, s48, 8
s_lshl_b32 s47, s47, 15
s_add_u32 s47, s47, s48
s_and_b32 s48, s43, 3
s_lshl_b32 s48, s48, 6
s_add_u32 s57, s47, s48
s_add_u32 s57, s57, 524288
s_add_u32 s58, s57, 0x40000
s_lshl_b32 s48, s44, 8
s_add_u32 s59, s59, s48
s_branch L_rdone
L_notleader:
v_mov_b32 v109, 0
v_mov_b32 v110, 0
s_cmp_eq_u32 s51, 1
s_cbranch_scc1 L_round0
s_branch L_rdone
L_round0:
L_round:
s_lshl_b32 s47, s100, 3
s_lshr_b32 s95, 269223938, s47
s_and_b32 s95, s95, 0xff
L_pr19:
s_memtime s[96:97]
s_and_b32 s49, s69, 0x3df80
s_xor_b32 s49, s49, s94
s_waitcnt lgkmcnt(0)
s_buffer_load_dword s101, s[12:15], s49
s_waitcnt lgkmcnt(0)
s_memtime s[98:99]
s_waitcnt lgkmcnt(0)
s_sub_u32 s47, s98, s96
s_cmp_lt_u32 s47, 400
s_cselect_b32 s47, 0x10000, s47
s_bitcmp1_b32 s94, 13
s_cselect_b32 s48, 0x10000, s47
s_cselect_b32 s47, s47, 0x10000
s_min_u32 s92, s92, s48
s_min_u32 s93, s93, s47
s_xor_b32 s94, s94, 0x2000
s_add_u32 s69, s69, s98
s_mul_i32 s69, s69, 0x9e3779b1
s_lshr_b32 s47, s69, 14
s_xor_b32 s69, s69, s47
s_sub_u32 s95, s95, 1
s_cmp_lg_u32 s95, 0
s_cbranch_scc1 L_pr19
s_sub_i32 s92, s92, s93
s_min_i32 s92, s92, 200
s_max_i32 s92, s92, -200
s_lshl_b32 s47, s100, 2
s_mov_b64 exec, 1
v_mov_b32 v72, s47
v_mov_b32 v73, s92
v_mov_b32 v74, 1
ds_add_u32 v72, v73 offset:544
ds_add_u32 v72, v74 offset:528
s_cmp_lg_u32 s42, 1
s_cbranch_scc1 L_rnext
s_mov_b32 s52, 1048576
L_sp20:
ds_read_b32 v74, v72 offset:528
s_sub_u32 s52, s52, 1
s_cbranch_scc1 L_sp20x
s_waitcnt lgkmcnt(0)
v_cmp_ne_u32 vcc, 3, v74
s_cbranch_vccnz L_sp20
L_sp20x:
s_waitcnt lgkmcnt(0)
ds_read_b32 v76, v72 offset:544
v_mov_b32 v77, s74
v_mov_b32 v78, s74
v_mov_b32 v79, s74
s_lshl_b32 s47, s2, 8
s_lshl_b32 s48, s100, 6
s_add_u32 s47, s47, s48
s_add_u32 s47, s47, 1572864
s_xor_b32 s48, s47, 0x400
s_waitcnt lgkmcnt(0)
buffer_store_dwordx4 v[76:79], off, s[8:11], s47 sc1
s_mov_b32 s52, 131072
L_sp21:
buffer_load_dwordx4 v[80:83], off, s[8:11], s48 sc1
s_sub_u32 s52, s52, 1
s_cbranch_scc1 L_sp21x
s_waitcnt vmcnt(0)
v_xor_b32 v81, s74, v81
v_xor_b32 v82, s74, v82
v_or_b32 v81, v81, v82
v_cmp_ne_u32 vcc, 0, v81
s_cbranch_vccnz L_sp21
L_sp21x:
s_waitcnt vmcnt(0)
v_sub_u32 v74, v76, v80
v_sub_u32 v75, v80, v76
s_cmp_eq_u32 s46, 0
s_cselect_b64 vcc, -1, 0
v_cndmask_b32 v74, v75, v74, vcc
v_cmp_lt_i32 vcc, 0, v74
s_nop 1
v_cndmask_b32 v74, 0, 1, vcc
v_xor_b32 v74, s46, v74
ds_write_b32 v72, v74 offset:576
L_rnext:
s_mov_b64 exec, -1
s_add_u32 s100, s100, 1
s_mov_b64 s[12:13], s[28:29]
s_cmp_eq_u32 s100, 1
s_cselect_b64 s[12:13], s[30:31], s[12:13]
s_cmp_eq_u32 s100, 2
s_cselect_b64 s[12:13], s[18:19], s[12:13]
s_cmp_eq_u32 s100, 3
s_cselect_b64 s[12:13], s[20:21], s[12:13]
s_mov_b32 s14, 0x10000000
s_mov_b32 s92, 0x10000
s_mov_b32 s93, 0x10000
s_cmp_lt_u32 s100, 4
s_cbranch_scc1 L_round
L_rdone:
s_lshl_b32 s47, s46, 1
v_and_or_b32 v72, v2, 1, s47
v_xor_b32 v73, s42, v72
v_lshlrev_b32 v108, 8, v73
v_lshl_add_u32 v108, v72, 15, v108
v_lshrrev_b32 v73, 5, v0
v_lshl_add_u32 v108, v73, 10, v108
v_lshl_add_u32 v108, v3, 4, v108
v_and_b32 v72, 31, v0
v_lshlrev_b32 v4, 3, v72
v_lshl_add_u32 v4, v73, 2, v4
s_lshl_b32 s47, s42, 8
v_add_u32 v4, s47, v4
s_and_b32 s48, s43, 15
s_lshl_b32 s56, s48, 11
s_lshr_b32 s48, s43, 4
s_lshl_b32 s48, s48, 17
s_add_u32 s56, s56, s48
s_add_u32 s56, s56, 1048576
v_lshl_add_u32 v104, v2, 15, v6
s_lshl_b32 s47, s46, 2
s_or_b32 s47, s47, s45
s_lshl_b32 s47, s47, 8
v_xor_b32 v104, s47, v104
s_add_u32 s74, s74, 1
s_and_b32 s47, s74, 0xff
v_mov_b32 v116, s47
s_lshr_b32 s47, s74, 8
s_xor_b32 s47, s47, s74
s_and_b32 s47, s47, 0xff
v_mov_b32 v117, s47
s_lshr_b32 s47, s74, 16
s_xor_b32 s47, s47, s74
s_and_b32 s47, s47, 0xff
v_mov_b32 v118, s47
s_lshr_b32 s47, s74, 24
s_xor_b32 s47, s47, s74
s_and_b32 s47, s47, 0xff
v_mov_b32 v119, s47
s_getreg_b32 s94, hwreg(HW_REG_XCC_ID, 0, 4)
v_xor_b32 v119, s94, v119
s_mov_b32 s12, s36
s_mov_b32 s13, s37
s_mov_b32 s14, 8192
s_mov_b32 s52, 131072
s_cmp_lg_u32 s42, s45
s_waitcnt lgkmcnt(0)
s_barrier
s_cbranch_scc1 L_x3first
ds_read_b128 v[72:75], v6 offset:10240
ds_read_b128 v[76:79], v6 offset:11264
ds_read_b128 v[80:83], v6 offset:12288
ds_read_b128 v[84:87], v6 offset:13312
s_waitcnt lgkmcnt(2)
v_add_f32 v64, v72, v76
v_add_f32 v65, v73, v77
v_add_f32 v66, v74, v78
v_add_f32 v67, v75, v79
s_waitcnt lgkmcnt(0)
v_add_f32 v80, v80, v84
v_add_f32 v81, v81, v85
v_add_f32 v82, v82, v86
v_add_f32 v83, v83, v87
v_add_f32 v64, v64, v80
v_add_f32 v65, v65, v81
v_add_f32 v66, v66, v82
v_add_f32 v67, v67, v83
v_and_or_b32 v64, v64, s76, v112
v_and_or_b32 v65, v65, s76, v113
v_and_or_b32 v66, v66, s76, v114
v_and_or_b32 v67, v67, s76, v115
buffer_store_dwordx4 v[64:67], v104, s[8:11], s56 offen sc1
v_xor_b32 v72, v64, v112
v_xor_b32 v73, v65, v113
v_xor_b32 v74, v66, v114
v_xor_b32 v75, v67, v115
s_cmp_eq_u32 s46, 0
s_cselect_b32 exec_lo, 0, -1
s_cselect_b32 exec_hi, -1, 0
L_x3first:
buffer_load_dwordx4 v[72:75], v108, s[8:11], s56 offen sc1
s_barrier
s_branch L_x3w
L_x3spin:
buffer_load_dwordx4 v[72:75], v108, s[8:11], s56 offen sc1
L_x3w:
s_sub_u32 s52, s52, 1
s_cbranch_scc1 L_x3out
s_waitcnt vmcnt(0)
v_xor_b32 v72, v72, v112
v_xor_b32 v73, v73, v113
v_xor_b32 v74, v74, v114
v_xor_b32 v75, v75, v115
v_or3_b32 v76, v72, v73, v74
v_bitop3_b32 v76, v76, v75, s76 bitop3:0x54
v_cmp_ne_u32 vcc, 0, v76
s_cbranch_vccnz L_x3spin
L_x3out:
s_mov_b64 exec, -1
s_waitcnt vmcnt(0)
v_permlane32_swap_b32 v72, v74
v_permlane32_swap_b32 v73, v75
s_cmp_lg_u32 s42, 0
v_add_f32 v72, v72, v74
v_add_f32 v73, v73, v75
v_cvt_pk_bf16_f32 v72, v72, v73
ds_write_b32 v4, v72 offset:2048
s_waitcnt lgkmcnt(0)
s_barrier
s_cbranch_scc1 L_end
s_barrier
s_mov_b32 s52, 48
L_x4:
buffer_load_dwordx4 v[72:75], v109, s[8:11], s57 offen sc1
buffer_load_dwordx4 v[76:79], v109, s[8:11], s58 offen sc1
s_sub_u32 s52, s52, 1
s_cbranch_scc1 L_x4s
s_waitcnt vmcnt(0)
v_xor_b32 v72, v72, v116
v_xor_b32 v73, v73, v117
v_xor_b32 v74, v74, v118
v_xor_b32 v75, v75, v119
v_xor_b32 v76, v76, v116
v_xor_b32 v77, v77, v117
v_xor_b32 v78, v78, v118
v_xor_b32 v79, v79, v119
v_or3_b32 v80, v72, v73, v74
v_or3_b32 v80, v80, v75, v76
v_or3_b32 v80, v80, v77, v78
v_bitop3_b32 v80, v80, v79, s76 bitop3:0x54
v_cmp_ne_u32 vcc, 0, v80
s_cbranch_vccnz L_x4
L_x4x:
v_add_f32 v72, v72, v76
v_add_f32 v73, v73, v77
v_add_f32 v74, v74, v78
v_add_f32 v75, v75, v79
v_add_f32_dpp v76, v72, v72 row_ror:8 row_mask:0xf bank_mask:0x3
v_add_f32_dpp v77, v73, v73 row_ror:8 row_mask:0xf bank_mask:0x3
s_nop 0
v_add_f32_dpp v76, v74, v74 row_ror:8 row_mask:0xf bank_mask:0xc
v_add_f32_dpp v77, v75, v75 row_ror:8 row_mask:0xf bank_mask:0xc
s_nop 0
v_add_f32_dpp v72, v76, v76 row_shl:4 row_mask:0xf bank_mask:0x5
s_nop 1
v_add_f32_dpp v72, v77, v77 row_shr:4 row_mask:0xf bank_mask:0xa
v_mov_b32 v73, v72
s_nop 1
v_permlane16_swap_b32 v73, v72
s_nop 0
v_add_f32 v72, v72, v73
v_mov_b32 v73, v72
s_nop 1
v_permlane32_swap_b32 v73, v72
s_nop 0
v_add_f32 v72, v72, v73
v_cvt_pk_bf16_f32 v72, v72, v72
s_mov_b64 exec, 0xffff
buffer_store_short v72, v110, s[12:15], s59 offen
s_cmp_lg_u32 s2, 0
s_cbranch_scc1 L_end
s_mov_b64 exec, 1
v_mov_b32 v74, s74
s_mov_b32 s47, 1376256
buffer_store_dword v74, off, s[8:11], s47
L_end:
s_endpgm
L_x4s:
ds_read_b128 v[64:67], v6 offset:14336
ds_read_b128 v[68:71], v6 offset:15360
s_waitcnt lgkmcnt(0)
v_xor_b32 v67, s94, v67
v_xor_b32 v71, s94, v71
v_xor_b32 v104, 0x100, v5
buffer_store_dwordx4 v[64:67], v5, s[8:11], s54 offen sc1
buffer_store_dwordx4 v[68:71], v104, s[8:11], s54 offen sc1
s_waitcnt vmcnt(0)
s_mov_b32 s52, 131072
L_sp22:
s_xor_b32 s57, s57, 524288
s_xor_b32 s58, s58, 524288
v_xor_b32 v119, s94, v119
buffer_load_dwordx4 v[72:75], v109, s[8:11], s57 offen sc1
buffer_load_dwordx4 v[76:79], v109, s[8:11], s58 offen sc1
s_sub_u32 s52, s52, 1
s_cbranch_scc1 L_sp22x
s_waitcnt vmcnt(0)
v_xor_b32 v72, v72, v116
v_xor_b32 v73, v73, v117
v_xor_b32 v74, v74, v118
v_xor_b32 v75, v75, v119
v_xor_b32 v76, v76, v116
v_xor_b32 v77, v77, v117
v_xor_b32 v78, v78, v118
v_xor_b32 v79, v79, v119
v_or3_b32 v80, v72, v73, v74
v_or3_b32 v80, v80, v75, v76
v_or3_b32 v80, v80, v77, v78
v_bitop3_b32 v80, v80, v79, s76 bitop3:0x54
v_cmp_ne_u32 vcc, 0, v80
s_cbranch_vccnz L_sp22
L_sp22x:
s_waitcnt vmcnt(0)
s_branch L_x4x
.section .rodata,"a"
.p2align 6
.amdhsa_kernel concat_heads__gqa_block_cached__sliding_block_cached__decode_kernel
  .amdhsa_next_free_vgpr 256
  .amdhsa_next_free_sgpr 102
  .amdhsa_accum_offset 256
  .amdhsa_group_segment_fixed_size 0
  .amdhsa_kernarg_size 104
  .amdhsa_user_sgpr_count 2
  .amdhsa_user_sgpr_kernarg_segment_ptr 1
  .amdhsa_system_sgpr_workgroup_id_x 1
  .amdhsa_float_denorm_mode_32 3
.end_amdhsa_kernel
```
